```python
import torch

def _softmax(x, axis=-1):
    return torch.softmax(x, dim=axis)
def _gelu(x):
    return torch.nn.functional.gelu(x, approximate="tanh")
def _silu(x):
    return torch.nn.functional.silu(x)
def _sigmoid(x):
    return torch.sigmoid(x)
def _layernorm(x, axis=-1, eps=1e-5):
    m = x.mean(dim=axis, keepdim=True)
    v = x.var(dim=axis, keepdim=True, unbiased=False)
    return (x - m) / torch.sqrt(v + eps)
def _scatter_add(tgt, idx, src, axis=0):
    return tgt.clone().index_add_(axis, idx, src)
def _segment_sum(src, seg, n):
    out = torch.zeros((n,) + src.shape[1:], dtype=src.dtype)
    return out.index_add_(0, seg, src)
def _pad(x, pw):
    flat = tuple(v for pair in reversed(pw) for v in pair)
    return torch.nn.functional.pad(x, flat)

kernel_name = 'gather_scatter__molecular_angular_gemnet__graph'

def setup_inputs():

    _w = (lambda a: (lambda t: t.to(torch.bfloat16) if t.is_floating_point() else t)(torch.as_tensor(a)))
    N, deg, De, L = 10000, 32, 16, 3
    E = N * deg
    T = E * deg
    NR = 8
    dist = torch.rand(E).to(float)
    angle = (torch.rand(T) * torch.pi).to(float)
    centers = torch.linspace(0.0, 1.0, NR).to(float)
    ang_freq = torch.arange(1, L + 1).to(float)
    return {
        "m": _w((lambda *s: torch.randn(*s, dtype=torch.bfloat16) * 0.05)(E, De)),
        "idx_in": _w((lambda lo, hi, *s: torch.randint(lo, hi, s))(0, E, T).to(torch.int64)),
        "idx_out": _w((lambda lo, hi, *s: torch.randint(lo, hi, s))(0, E, T).to(torch.int64)),
        "dist": _w(dist),
        "angle": _w(angle),
        "centers": _w(centers),
        "ang_freq": _w(ang_freq),
        "w_rbf": _w((lambda *s: torch.randn(*s, dtype=torch.bfloat16) * 0.2)(NR, De)),
        "w_sbf": _w((lambda *s: torch.randn(*s, dtype=torch.bfloat16) * 0.2)(NR * L, De)),
        "w_down": _w((lambda *s: torch.randn(*s, dtype=torch.bfloat16) * 0.2)(De, De)),
        "w_up": _w((lambda *s: torch.randn(*s, dtype=torch.bfloat16) * 0.2)(De, De)),
    }

def reference(m, idx_in, idx_out, dist, angle, centers, ang_freq, w_rbf, w_sbf, w_down, w_up):
    E, De = m.shape[0], m.shape[1]
    NR = centers.shape[0]
    L = ang_freq.shape[0]
    rbf = torch.exp(-10.0 * (dist[:, None] - centers[None, :]) ** 2)
    cbf = torch.cos(ang_freq[None, :] * angle[:, None])
    rbf_t = rbf[idx_out]
    sbf = torch.reshape(rbf_t[:, :, None] * cbf[:, None, :], (-1, NR * L))
    x = (m[idx_in] @ w_down) * (sbf @ w_sbf)
    agg = _segment_sum(x, idx_out, E)
    return m + (agg @ w_up) * (rbf @ w_rbf)
```

```asm
; @launch kernel=k1_kernel grid=(250,1,1) block=(1024,1,1) lds=163840
; @launch kernel=k2_kernel grid=(250,1,1) block=(1024,1,1) lds=155648
.amdgcn_target "amdgcn-amd-amdhsa--gfx950"
.text
.globl k1_kernel
.p2align 8
.type k1_kernel,@function
k1_kernel:
    s_cmp_ge_u32 s2, 250
    s_cbranch_scc1 k1_end
    s_load_dwordx4 s[4:7], s[0:1], 8
    s_load_dwordx2 s[8:9], s[0:1], 32
    s_load_dwordx2 s[10:11], s[0:1], 104
    v_lshlrev_b32 v1, 3, v0
    v_mov_b32 v2, 0
    v_mov_b32 v3, 0
    ds_write_b64 v1, v[2:3]
    v_lshlrev_b32 v4, 4, v0
    v_mov_b32 v6, 1
    s_mul_i32 s36, s2, 163840
    s_mul_i32 s37, s2, 81920
    s_mul_i32 s38, s2, 5000
    s_waitcnt lgkmcnt(0)
    s_add_u32 s12, s4, s36
    s_addc_u32 s13, s5, 0
    s_mov_b32 s14, 163840
    s_mov_b32 s15, 0x00020000
    s_add_u32 s16, s6, s36
    s_addc_u32 s17, s7, 0
    s_mov_b32 s18, 163840
    s_mov_b32 s19, 0x00020000
    s_add_u32 s20, s8, s37
    s_addc_u32 s21, s9, 0
    s_mov_b32 s22, 81920
    s_mov_b32 s23, 0x00020000
    s_add_u32 s24, s10, s36
    s_addc_u32 s25, s11, 0
    s_mov_b32 s26, 163840
    s_mov_b32 s27, 0x00020000
    s_add_u32 s37, s37, 40960000
    s_add_u32 s28, s10, s37
    s_addc_u32 s29, s11, 0
    s_mov_b32 s30, 81920
    s_mov_b32 s31, 0x00020000
    s_add_u32 s38, s38, 61440000
    s_add_u32 s32, s10, s38
    s_addc_u32 s33, s11, 0
    s_mov_b32 s34, 5000
    s_mov_b32 s35, 0x00020000
    s_mov_b32 s40, 0
    s_mov_b32 s50, 0
    s_mov_b32 s41, 16384
    s_mov_b32 s51, 8192
    s_mov_b32 s42, 32768
    s_mov_b32 s52, 16384
    s_mov_b32 s43, 49152
    s_mov_b32 s53, 24576
    s_mov_b32 s44, 65536
    s_mov_b32 s54, 32768
    s_mov_b32 s45, 81920
    s_mov_b32 s55, 40960
    s_mov_b32 s46, 98304
    s_mov_b32 s56, 49152
    s_mov_b32 s47, 114688
    s_mov_b32 s57, 57344
    s_mov_b32 s48, 131072
    s_mov_b32 s58, 65536
    s_mov_b32 s49, 147456
    s_mov_b32 s59, 73728
    s_mov_b32 s39, 0xfffffb00
    s_movk_i32 s60, 1000
    s_mov_b32 s61, 0x05040100
    s_mov_b32 s62, 0x07060100
    s_movk_i32 s63, 5120
    buffer_load_dwordx4 v[8:11], v4, s[16:19], s40 offen nt
    buffer_load_dwordx4 v[48:51], v4, s[12:15], s40 offen nt
    buffer_load_dwordx2 v[88:89], v1, s[20:23], s50 offen nt
    buffer_load_dwordx4 v[12:15], v4, s[16:19], s41 offen nt
    buffer_load_dwordx4 v[52:55], v4, s[12:15], s41 offen nt
    buffer_load_dwordx2 v[90:91], v1, s[20:23], s51 offen nt
    buffer_load_dwordx4 v[16:19], v4, s[16:19], s42 offen nt
    buffer_load_dwordx4 v[56:59], v4, s[12:15], s42 offen nt
    buffer_load_dwordx2 v[92:93], v1, s[20:23], s52 offen nt
    buffer_load_dwordx4 v[20:23], v4, s[16:19], s43 offen nt
    buffer_load_dwordx4 v[60:63], v4, s[12:15], s43 offen nt
    buffer_load_dwordx2 v[94:95], v1, s[20:23], s53 offen nt
    s_barrier
    s_waitcnt vmcnt(9)
    v_lshrrev_b32 v108, 8, v8
    v_lshrrev_b32 v109, 16, v48
    v_mul_u32_u24 v108, 52429, v108
    v_perm_b32 v48, v88, v48, s61
    v_lshrrev_b32 v108, 18, v108
    v_mad_i32_i24 v110, v108, s39, v8
    v_lshlrev_b32 v108, 2, v108
    v_mad_u32_u24 v8, v109, s60, v108
    v_and_b32 v108, 1, v109
    v_lshrrev_b32 v109, 4, v110
    ds_add_u32 v8, v6
    v_mad_u32_u24 v110, v109, 48, v110
    v_mad_u32_u24 v110, v108, s63, v110
    v_lshrrev_b32 v111, 8, v9
    v_lshrrev_b32 v112, 16, v49
    v_mul_u32_u24 v111, 52429, v111
    v_perm_b32 v49, v88, v49, s62
    v_lshrrev_b32 v111, 18, v111
    v_mad_i32_i24 v113, v111, s39, v9
    v_lshlrev_b32 v111, 2, v111
    v_mad_u32_u24 v9, v112, s60, v111
    v_and_b32 v111, 1, v112
    v_lshrrev_b32 v112, 4, v113
    ds_add_u32 v9, v6
    v_mad_u32_u24 v113, v112, 48, v113
    v_mad_u32_u24 v113, v111, s63, v113
    v_lshl_or_b32 v88, v113, 16, v110
    v_lshrrev_b32 v114, 8, v10
    v_lshrrev_b32 v115, 16, v50
    v_mul_u32_u24 v114, 52429, v114
    v_perm_b32 v50, v89, v50, s61
    v_lshrrev_b32 v114, 18, v114
    v_mad_i32_i24 v116, v114, s39, v10
    v_lshlrev_b32 v114, 2, v114
    v_mad_u32_u24 v10, v115, s60, v114
    v_and_b32 v114, 1, v115
    v_lshrrev_b32 v115, 4, v116
    ds_add_u32 v10, v6
    v_mad_u32_u24 v116, v115, 48, v116
    v_mad_u32_u24 v116, v114, s63, v116
    v_lshrrev_b32 v117, 8, v11
    v_lshrrev_b32 v118, 16, v51
    v_mul_u32_u24 v117, 52429, v117
    v_perm_b32 v51, v89, v51, s62
    v_lshrrev_b32 v117, 18, v117
    v_mad_i32_i24 v119, v117, s39, v11
    v_lshlrev_b32 v117, 2, v117
    v_mad_u32_u24 v11, v118, s60, v117
    v_and_b32 v117, 1, v118
    v_lshrrev_b32 v118, 4, v119
    ds_add_u32 v11, v6
    v_mad_u32_u24 v119, v118, 48, v119
    v_mad_u32_u24 v119, v117, s63, v119
    v_lshl_or_b32 v89, v119, 16, v116
    buffer_load_dwordx4 v[24:27], v4, s[16:19], s44 offen nt
    buffer_load_dwordx4 v[64:67], v4, s[12:15], s44 offen nt
    buffer_load_dwordx2 v[96:97], v1, s[20:23], s54 offen nt
    s_waitcnt vmcnt(9)
    v_lshrrev_b32 v108, 8, v12
    v_lshrrev_b32 v109, 16, v52
    v_mul_u32_u24 v108, 52429, v108
    v_perm_b32 v52, v90, v52, s61
    v_lshrrev_b32 v108, 18, v108
    v_mad_i32_i24 v110, v108, s39, v12
    v_lshlrev_b32 v108, 2, v108
    v_mad_u32_u24 v12, v109, s60, v108
    v_and_b32 v108, 1, v109
    v_lshrrev_b32 v109, 4, v110
    ds_add_u32 v12, v6
    v_mad_u32_u24 v110, v109, 48, v110
    v_mad_u32_u24 v110, v108, s63, v110
    v_lshrrev_b32 v111, 8, v13
    v_lshrrev_b32 v112, 16, v53
    v_mul_u32_u24 v111, 52429, v111
    v_perm_b32 v53, v90, v53, s62
    v_lshrrev_b32 v111, 18, v111
    v_mad_i32_i24 v113, v111, s39, v13
    v_lshlrev_b32 v111, 2, v111
    v_mad_u32_u24 v13, v112, s60, v111
    v_and_b32 v111, 1, v112
    v_lshrrev_b32 v112, 4, v113
    ds_add_u32 v13, v6
    v_mad_u32_u24 v113, v112, 48, v113
    v_mad_u32_u24 v113, v111, s63, v113
    v_lshl_or_b32 v90, v113, 16, v110
    v_lshrrev_b32 v114, 8, v14
    v_lshrrev_b32 v115, 16, v54
    v_mul_u32_u24 v114, 52429, v114
    v_perm_b32 v54, v91, v54, s61
    v_lshrrev_b32 v114, 18, v114
    v_mad_i32_i24 v116, v114, s39, v14
    v_lshlrev_b32 v114, 2, v114
    v_mad_u32_u24 v14, v115, s60, v114
    v_and_b32 v114, 1, v115
    v_lshrrev_b32 v115, 4, v116
    ds_add_u32 v14, v6
    v_mad_u32_u24 v116, v115, 48, v116
    v_mad_u32_u24 v116, v114, s63, v116
    v_lshrrev_b32 v117, 8, v15
    v_lshrrev_b32 v118, 16, v55
    v_mul_u32_u24 v117, 52429, v117
    v_perm_b32 v55, v91, v55, s62
    v_lshrrev_b32 v117, 18, v117
    v_mad_i32_i24 v119, v117, s39, v15
    v_lshlrev_b32 v117, 2, v117
    v_mad_u32_u24 v15, v118, s60, v117
    v_and_b32 v117, 1, v118
    v_lshrrev_b32 v118, 4, v119
    ds_add_u32 v15, v6
    v_mad_u32_u24 v119, v118, 48, v119
    v_mad_u32_u24 v119, v117, s63, v119
    v_lshl_or_b32 v91, v119, 16, v116
    buffer_load_dwordx4 v[28:31], v4, s[16:19], s45 offen nt
    buffer_load_dwordx4 v[68:71], v4, s[12:15], s45 offen nt
    buffer_load_dwordx2 v[98:99], v1, s[20:23], s55 offen nt
    s_waitcnt vmcnt(9)
    v_lshrrev_b32 v108, 8, v16
    v_lshrrev_b32 v109, 16, v56
    v_mul_u32_u24 v108, 52429, v108
    v_perm_b32 v56, v92, v56, s61
    v_lshrrev_b32 v108, 18, v108
    v_mad_i32_i24 v110, v108, s39, v16
    v_lshlrev_b32 v108, 2, v108
    v_mad_u32_u24 v16, v109, s60, v108
    v_and_b32 v108, 1, v109
    v_lshrrev_b32 v109, 4, v110
    ds_add_u32 v16, v6
    v_mad_u32_u24 v110, v109, 48, v110
    v_mad_u32_u24 v110, v108, s63, v110
    v_lshrrev_b32 v111, 8, v17
    v_lshrrev_b32 v112, 16, v57
    v_mul_u32_u24 v111, 52429, v111
    v_perm_b32 v57, v92, v57, s62
    v_lshrrev_b32 v111, 18, v111
    v_mad_i32_i24 v113, v111, s39, v17
    v_lshlrev_b32 v111, 2, v111
    v_mad_u32_u24 v17, v112, s60, v111
    v_and_b32 v111, 1, v112
    v_lshrrev_b32 v112, 4, v113
    ds_add_u32 v17, v6
    v_mad_u32_u24 v113, v112, 48, v113
    v_mad_u32_u24 v113, v111, s63, v113
    v_lshl_or_b32 v92, v113, 16, v110
    v_lshrrev_b32 v114, 8, v18
    v_lshrrev_b32 v115, 16, v58
    v_mul_u32_u24 v114, 52429, v114
    v_perm_b32 v58, v93, v58, s61
    v_lshrrev_b32 v114, 18, v114
    v_mad_i32_i24 v116, v114, s39, v18
    v_lshlrev_b32 v114, 2, v114
    v_mad_u32_u24 v18, v115, s60, v114
    v_and_b32 v114, 1, v115
    v_lshrrev_b32 v115, 4, v116
    ds_add_u32 v18, v6
    v_mad_u32_u24 v116, v115, 48, v116
    v_mad_u32_u24 v116, v114, s63, v116
    v_lshrrev_b32 v117, 8, v19
    v_lshrrev_b32 v118, 16, v59
    v_mul_u32_u24 v117, 52429, v117
    v_perm_b32 v59, v93, v59, s62
    v_lshrrev_b32 v117, 18, v117
    v_mad_i32_i24 v119, v117, s39, v19
    v_lshlrev_b32 v117, 2, v117
    v_mad_u32_u24 v19, v118, s60, v117
    v_and_b32 v117, 1, v118
    v_lshrrev_b32 v118, 4, v119
    ds_add_u32 v19, v6
    v_mad_u32_u24 v119, v118, 48, v119
    v_mad_u32_u24 v119, v117, s63, v119
    v_lshl_or_b32 v93, v119, 16, v116
    buffer_load_dwordx4 v[32:35], v4, s[16:19], s46 offen nt
    buffer_load_dwordx4 v[72:75], v4, s[12:15], s46 offen nt
    buffer_load_dwordx2 v[100:101], v1, s[20:23], s56 offen nt
    s_waitcnt vmcnt(9)
    v_lshrrev_b32 v108, 8, v20
    v_lshrrev_b32 v109, 16, v60
    v_mul_u32_u24 v108, 52429, v108
    v_perm_b32 v60, v94, v60, s61
    v_lshrrev_b32 v108, 18, v108
    v_mad_i32_i24 v110, v108, s39, v20
    v_lshlrev_b32 v108, 2, v108
    v_mad_u32_u24 v20, v109, s60, v108
    v_and_b32 v108, 1, v109
    v_lshrrev_b32 v109, 4, v110
    ds_add_u32 v20, v6
    v_mad_u32_u24 v110, v109, 48, v110
    v_mad_u32_u24 v110, v108, s63, v110
    v_lshrrev_b32 v111, 8, v21
    v_lshrrev_b32 v112, 16, v61
    v_mul_u32_u24 v111, 52429, v111
    v_perm_b32 v61, v94, v61, s62
    v_lshrrev_b32 v111, 18, v111
    v_mad_i32_i24 v113, v111, s39, v21
    v_lshlrev_b32 v111, 2, v111
    v_mad_u32_u24 v21, v112, s60, v111
    v_and_b32 v111, 1, v112
    v_lshrrev_b32 v112, 4, v113
    ds_add_u32 v21, v6
    v_mad_u32_u24 v113, v112, 48, v113
    v_mad_u32_u24 v113, v111, s63, v113
    v_lshl_or_b32 v94, v113, 16, v110
    v_lshrrev_b32 v114, 8, v22
    v_lshrrev_b32 v115, 16, v62
    v_mul_u32_u24 v114, 52429, v114
    v_perm_b32 v62, v95, v62, s61
    v_lshrrev_b32 v114, 18, v114
    v_mad_i32_i24 v116, v114, s39, v22
    v_lshlrev_b32 v114, 2, v114
    v_mad_u32_u24 v22, v115, s60, v114
    v_and_b32 v114, 1, v115
    v_lshrrev_b32 v115, 4, v116
    ds_add_u32 v22, v6
    v_mad_u32_u24 v116, v115, 48, v116
    v_mad_u32_u24 v116, v114, s63, v116
    v_lshrrev_b32 v117, 8, v23
    v_lshrrev_b32 v118, 16, v63
    v_mul_u32_u24 v117, 52429, v117
    v_perm_b32 v63, v95, v63, s62
    v_lshrrev_b32 v117, 18, v117
    v_mad_i32_i24 v119, v117, s39, v23
    v_lshlrev_b32 v117, 2, v117
    v_mad_u32_u24 v23, v118, s60, v117
    v_and_b32 v117, 1, v118
    v_lshrrev_b32 v118, 4, v119
    ds_add_u32 v23, v6
    v_mad_u32_u24 v119, v118, 48, v119
    v_mad_u32_u24 v119, v117, s63, v119
    v_lshl_or_b32 v95, v119, 16, v116
    buffer_load_dwordx4 v[36:39], v4, s[16:19], s47 offen nt
    buffer_load_dwordx4 v[76:79], v4, s[12:15], s47 offen nt
    buffer_load_dwordx2 v[102:103], v1, s[20:23], s57 offen nt
    s_waitcnt vmcnt(9)
    v_lshrrev_b32 v108, 8, v24
    v_lshrrev_b32 v109, 16, v64
    v_mul_u32_u24 v108, 52429, v108
    v_perm_b32 v64, v96, v64, s61
    v_lshrrev_b32 v108, 18, v108
    v_mad_i32_i24 v110, v108, s39, v24
    v_lshlrev_b32 v108, 2, v108
    v_mad_u32_u24 v24, v109, s60, v108
    v_and_b32 v108, 1, v109
    v_lshrrev_b32 v109, 4, v110
    ds_add_u32 v24, v6
    v_mad_u32_u24 v110, v109, 48, v110
    v_mad_u32_u24 v110, v108, s63, v110
    v_lshrrev_b32 v111, 8, v25
    v_lshrrev_b32 v112, 16, v65
    v_mul_u32_u24 v111, 52429, v111
    v_perm_b32 v65, v96, v65, s62
    v_lshrrev_b32 v111, 18, v111
    v_mad_i32_i24 v113, v111, s39, v25
    v_lshlrev_b32 v111, 2, v111
    v_mad_u32_u24 v25, v112, s60, v111
    v_and_b32 v111, 1, v112
    v_lshrrev_b32 v112, 4, v113
    ds_add_u32 v25, v6
    v_mad_u32_u24 v113, v112, 48, v113
    v_mad_u32_u24 v113, v111, s63, v113
    v_lshl_or_b32 v96, v113, 16, v110
    v_lshrrev_b32 v114, 8, v26
    v_lshrrev_b32 v115, 16, v66
    v_mul_u32_u24 v114, 52429, v114
    v_perm_b32 v66, v97, v66, s61
    v_lshrrev_b32 v114, 18, v114
    v_mad_i32_i24 v116, v114, s39, v26
    v_lshlrev_b32 v114, 2, v114
    v_mad_u32_u24 v26, v115, s60, v114
    v_and_b32 v114, 1, v115
    v_lshrrev_b32 v115, 4, v116
    ds_add_u32 v26, v6
    v_mad_u32_u24 v116, v115, 48, v116
    v_mad_u32_u24 v116, v114, s63, v116
    v_lshrrev_b32 v117, 8, v27
    v_lshrrev_b32 v118, 16, v67
    v_mul_u32_u24 v117, 52429, v117
    v_perm_b32 v67, v97, v67, s62
    v_lshrrev_b32 v117, 18, v117
    v_mad_i32_i24 v119, v117, s39, v27
    v_lshlrev_b32 v117, 2, v117
    v_mad_u32_u24 v27, v118, s60, v117
    v_and_b32 v117, 1, v118
    v_lshrrev_b32 v118, 4, v119
    ds_add_u32 v27, v6
    v_mad_u32_u24 v119, v118, 48, v119
    v_mad_u32_u24 v119, v117, s63, v119
    v_lshl_or_b32 v97, v119, 16, v116
    buffer_load_dwordx4 v[40:43], v4, s[16:19], s48 offen nt
    buffer_load_dwordx4 v[80:83], v4, s[12:15], s48 offen nt
    buffer_load_dwordx2 v[104:105], v1, s[20:23], s58 offen nt
    s_waitcnt vmcnt(9)
    v_lshrrev_b32 v108, 8, v28
    v_lshrrev_b32 v109, 16, v68
    v_mul_u32_u24 v108, 52429, v108
    v_perm_b32 v68, v98, v68, s61
    v_lshrrev_b32 v108, 18, v108
    v_mad_i32_i24 v110, v108, s39, v28
    v_lshlrev_b32 v108, 2, v108
    v_mad_u32_u24 v28, v109, s60, v108
    v_and_b32 v108, 1, v109
    v_lshrrev_b32 v109, 4, v110
    ds_add_u32 v28, v6
    v_mad_u32_u24 v110, v109, 48, v110
    v_mad_u32_u24 v110, v108, s63, v110
    v_lshrrev_b32 v111, 8, v29
    v_lshrrev_b32 v112, 16, v69
    v_mul_u32_u24 v111, 52429, v111
    v_perm_b32 v69, v98, v69, s62
    v_lshrrev_b32 v111, 18, v111
    v_mad_i32_i24 v113, v111, s39, v29
    v_lshlrev_b32 v111, 2, v111
    v_mad_u32_u24 v29, v112, s60, v111
    v_and_b32 v111, 1, v112
    v_lshrrev_b32 v112, 4, v113
    ds_add_u32 v29, v6
    v_mad_u32_u24 v113, v112, 48, v113
    v_mad_u32_u24 v113, v111, s63, v113
    v_lshl_or_b32 v98, v113, 16, v110
    v_lshrrev_b32 v114, 8, v30
    v_lshrrev_b32 v115, 16, v70
    v_mul_u32_u24 v114, 52429, v114
    v_perm_b32 v70, v99, v70, s61
    v_lshrrev_b32 v114, 18, v114
    v_mad_i32_i24 v116, v114, s39, v30
    v_lshlrev_b32 v114, 2, v114
    v_mad_u32_u24 v30, v115, s60, v114
    v_and_b32 v114, 1, v115
    v_lshrrev_b32 v115, 4, v116
    ds_add_u32 v30, v6
    v_mad_u32_u24 v116, v115, 48, v116
    v_mad_u32_u24 v116, v114, s63, v116
    v_lshrrev_b32 v117, 8, v31
    v_lshrrev_b32 v118, 16, v71
    v_mul_u32_u24 v117, 52429, v117
    v_perm_b32 v71, v99, v71, s62
    v_lshrrev_b32 v117, 18, v117
    v_mad_i32_i24 v119, v117, s39, v31
    v_lshlrev_b32 v117, 2, v117
    v_mad_u32_u24 v31, v118, s60, v117
    v_and_b32 v117, 1, v118
    v_lshrrev_b32 v118, 4, v119
    ds_add_u32 v31, v6
    v_mad_u32_u24 v119, v118, 48, v119
    v_mad_u32_u24 v119, v117, s63, v119
    v_lshl_or_b32 v99, v119, 16, v116
    buffer_load_dwordx4 v[44:47], v4, s[16:19], s49 offen nt
    buffer_load_dwordx4 v[84:87], v4, s[12:15], s49 offen nt
    buffer_load_dwordx2 v[106:107], v1, s[20:23], s59 offen nt
    s_waitcnt vmcnt(9)
    v_lshrrev_b32 v108, 8, v32
    v_lshrrev_b32 v109, 16, v72
    v_mul_u32_u24 v108, 52429, v108
    v_perm_b32 v72, v100, v72, s61
    v_lshrrev_b32 v108, 18, v108
    v_mad_i32_i24 v110, v108, s39, v32
    v_lshlrev_b32 v108, 2, v108
    v_mad_u32_u24 v32, v109, s60, v108
    v_and_b32 v108, 1, v109
    v_lshrrev_b32 v109, 4, v110
    ds_add_u32 v32, v6
    v_mad_u32_u24 v110, v109, 48, v110
    v_mad_u32_u24 v110, v108, s63, v110
    v_lshrrev_b32 v111, 8, v33
    v_lshrrev_b32 v112, 16, v73
    v_mul_u32_u24 v111, 52429, v111
    v_perm_b32 v73, v100, v73, s62
    v_lshrrev_b32 v111, 18, v111
    v_mad_i32_i24 v113, v111, s39, v33
    v_lshlrev_b32 v111, 2, v111
    v_mad_u32_u24 v33, v112, s60, v111
    v_and_b32 v111, 1, v112
    v_lshrrev_b32 v112, 4, v113
    ds_add_u32 v33, v6
    v_mad_u32_u24 v113, v112, 48, v113
    v_mad_u32_u24 v113, v111, s63, v113
    v_lshl_or_b32 v100, v113, 16, v110
    v_lshrrev_b32 v114, 8, v34
    v_lshrrev_b32 v115, 16, v74
    v_mul_u32_u24 v114, 52429, v114
    v_perm_b32 v74, v101, v74, s61
    v_lshrrev_b32 v114, 18, v114
    v_mad_i32_i24 v116, v114, s39, v34
    v_lshlrev_b32 v114, 2, v114
    v_mad_u32_u24 v34, v115, s60, v114
    v_and_b32 v114, 1, v115
    v_lshrrev_b32 v115, 4, v116
    ds_add_u32 v34, v6
    v_mad_u32_u24 v116, v115, 48, v116
    v_mad_u32_u24 v116, v114, s63, v116
    v_lshrrev_b32 v117, 8, v35
    v_lshrrev_b32 v118, 16, v75
    v_mul_u32_u24 v117, 52429, v117
    v_perm_b32 v75, v101, v75, s62
    v_lshrrev_b32 v117, 18, v117
    v_mad_i32_i24 v119, v117, s39, v35
    v_lshlrev_b32 v117, 2, v117
    v_mad_u32_u24 v35, v118, s60, v117
    v_and_b32 v117, 1, v118
    v_lshrrev_b32 v118, 4, v119
    ds_add_u32 v35, v6
    v_mad_u32_u24 v119, v118, 48, v119
    v_mad_u32_u24 v119, v117, s63, v119
    v_lshl_or_b32 v101, v119, 16, v116
    s_waitcnt vmcnt(6)
    v_lshrrev_b32 v108, 8, v36
    v_lshrrev_b32 v109, 16, v76
    v_mul_u32_u24 v108, 52429, v108
    v_perm_b32 v76, v102, v76, s61
    v_lshrrev_b32 v108, 18, v108
    v_mad_i32_i24 v110, v108, s39, v36
    v_lshlrev_b32 v108, 2, v108
    v_mad_u32_u24 v36, v109, s60, v108
    v_and_b32 v108, 1, v109
    v_lshrrev_b32 v109, 4, v110
    ds_add_u32 v36, v6
    v_mad_u32_u24 v110, v109, 48, v110
    v_mad_u32_u24 v110, v108, s63, v110
    v_lshrrev_b32 v111, 8, v37
    v_lshrrev_b32 v112, 16, v77
    v_mul_u32_u24 v111, 52429, v111
    v_perm_b32 v77, v102, v77, s62
    v_lshrrev_b32 v111, 18, v111
    v_mad_i32_i24 v113, v111, s39, v37
    v_lshlrev_b32 v111, 2, v111
    v_mad_u32_u24 v37, v112, s60, v111
    v_and_b32 v111, 1, v112
    v_lshrrev_b32 v112, 4, v113
    ds_add_u32 v37, v6
    v_mad_u32_u24 v113, v112, 48, v113
    v_mad_u32_u24 v113, v111, s63, v113
    v_lshl_or_b32 v102, v113, 16, v110
    v_lshrrev_b32 v114, 8, v38
    v_lshrrev_b32 v115, 16, v78
    v_mul_u32_u24 v114, 52429, v114
    v_perm_b32 v78, v103, v78, s61
    v_lshrrev_b32 v114, 18, v114
    v_mad_i32_i24 v116, v114, s39, v38
    v_lshlrev_b32 v114, 2, v114
    v_mad_u32_u24 v38, v115, s60, v114
    v_and_b32 v114, 1, v115
    v_lshrrev_b32 v115, 4, v116
    ds_add_u32 v38, v6
    v_mad_u32_u24 v116, v115, 48, v116
    v_mad_u32_u24 v116, v114, s63, v116
    v_lshrrev_b32 v117, 8, v39
    v_lshrrev_b32 v118, 16, v79
    v_mul_u32_u24 v117, 52429, v117
    v_perm_b32 v79, v103, v79, s62
    v_lshrrev_b32 v117, 18, v117
    v_mad_i32_i24 v119, v117, s39, v39
    v_lshlrev_b32 v117, 2, v117
    v_mad_u32_u24 v39, v118, s60, v117
    v_and_b32 v117, 1, v118
    v_lshrrev_b32 v118, 4, v119
    ds_add_u32 v39, v6
    v_mad_u32_u24 v119, v118, 48, v119
    v_mad_u32_u24 v119, v117, s63, v119
    v_lshl_or_b32 v103, v119, 16, v116
    s_waitcnt vmcnt(3)
    v_lshrrev_b32 v108, 8, v40
    v_lshrrev_b32 v109, 16, v80
    v_mul_u32_u24 v108, 52429, v108
    v_perm_b32 v80, v104, v80, s61
    v_lshrrev_b32 v108, 18, v108
    v_mad_i32_i24 v110, v108, s39, v40
    v_lshlrev_b32 v108, 2, v108
    v_mad_u32_u24 v40, v109, s60, v108
    v_and_b32 v108, 1, v109
    v_lshrrev_b32 v109, 4, v110
    ds_add_u32 v40, v6
    v_mad_u32_u24 v110, v109, 48, v110
    v_mad_u32_u24 v110, v108, s63, v110
    v_lshrrev_b32 v111, 8, v41
    v_lshrrev_b32 v112, 16, v81
    v_mul_u32_u24 v111, 52429, v111
    v_perm_b32 v81, v104, v81, s62
    v_lshrrev_b32 v111, 18, v111
    v_mad_i32_i24 v113, v111, s39, v41
    v_lshlrev_b32 v111, 2, v111
    v_mad_u32_u24 v41, v112, s60, v111
    v_and_b32 v111, 1, v112
    v_lshrrev_b32 v112, 4, v113
    ds_add_u32 v41, v6
    v_mad_u32_u24 v113, v112, 48, v113
    v_mad_u32_u24 v113, v111, s63, v113
    v_lshl_or_b32 v104, v113, 16, v110
    v_lshrrev_b32 v114, 8, v42
    v_lshrrev_b32 v115, 16, v82
    v_mul_u32_u24 v114, 52429, v114
    v_perm_b32 v82, v105, v82, s61
    v_lshrrev_b32 v114, 18, v114
    v_mad_i32_i24 v116, v114, s39, v42
    v_lshlrev_b32 v114, 2, v114
    v_mad_u32_u24 v42, v115, s60, v114
    v_and_b32 v114, 1, v115
    v_lshrrev_b32 v115, 4, v116
    ds_add_u32 v42, v6
    v_mad_u32_u24 v116, v115, 48, v116
    v_mad_u32_u24 v116, v114, s63, v116
    v_lshrrev_b32 v117, 8, v43
    v_lshrrev_b32 v118, 16, v83
    v_mul_u32_u24 v117, 52429, v117
    v_perm_b32 v83, v105, v83, s62
    v_lshrrev_b32 v117, 18, v117
    v_mad_i32_i24 v119, v117, s39, v43
    v_lshlrev_b32 v117, 2, v117
    v_mad_u32_u24 v43, v118, s60, v117
    v_and_b32 v117, 1, v118
    v_lshrrev_b32 v118, 4, v119
    ds_add_u32 v43, v6
    v_mad_u32_u24 v119, v118, 48, v119
    v_mad_u32_u24 v119, v117, s63, v119
    v_lshl_or_b32 v105, v119, 16, v116
    s_waitcnt vmcnt(0)
    v_lshrrev_b32 v108, 8, v44
    v_lshrrev_b32 v109, 16, v84
    v_mul_u32_u24 v108, 52429, v108
    v_perm_b32 v84, v106, v84, s61
    v_lshrrev_b32 v108, 18, v108
    v_mad_i32_i24 v110, v108, s39, v44
    v_lshlrev_b32 v108, 2, v108
    v_mad_u32_u24 v44, v109, s60, v108
    v_and_b32 v108, 1, v109
    v_lshrrev_b32 v109, 4, v110
    ds_add_u32 v44, v6
    v_mad_u32_u24 v110, v109, 48, v110
    v_mad_u32_u24 v110, v108, s63, v110
    v_lshrrev_b32 v111, 8, v45
    v_lshrrev_b32 v112, 16, v85
    v_mul_u32_u24 v111, 52429, v111
    v_perm_b32 v85, v106, v85, s62
    v_lshrrev_b32 v111, 18, v111
    v_mad_i32_i24 v113, v111, s39, v45
    v_lshlrev_b32 v111, 2, v111
    v_mad_u32_u24 v45, v112, s60, v111
    v_and_b32 v111, 1, v112
    v_lshrrev_b32 v112, 4, v113
    ds_add_u32 v45, v6
    v_mad_u32_u24 v113, v112, 48, v113
    v_mad_u32_u24 v113, v111, s63, v113
    v_lshl_or_b32 v106, v113, 16, v110
    v_lshrrev_b32 v114, 8, v46
    v_lshrrev_b32 v115, 16, v86
    v_mul_u32_u24 v114, 52429, v114
    v_perm_b32 v86, v107, v86, s61
    v_lshrrev_b32 v114, 18, v114
    v_mad_i32_i24 v116, v114, s39, v46
    v_lshlrev_b32 v114, 2, v114
    v_mad_u32_u24 v46, v115, s60, v114
    v_and_b32 v114, 1, v115
    v_lshrrev_b32 v115, 4, v116
    ds_add_u32 v46, v6
    v_mad_u32_u24 v116, v115, 48, v116
    v_mad_u32_u24 v116, v114, s63, v116
    v_lshrrev_b32 v117, 8, v47
    v_lshrrev_b32 v118, 16, v87
    v_mul_u32_u24 v117, 52429, v117
    v_perm_b32 v87, v107, v87, s62
    v_lshrrev_b32 v117, 18, v117
    v_mad_i32_i24 v119, v117, s39, v47
    v_lshlrev_b32 v117, 2, v117
    v_mad_u32_u24 v47, v118, s60, v117
    v_and_b32 v117, 1, v118
    v_lshrrev_b32 v118, 4, v119
    ds_add_u32 v47, v6
    v_mad_u32_u24 v119, v118, 48, v119
    v_mad_u32_u24 v119, v117, s63, v119
    v_lshl_or_b32 v107, v119, 16, v116
    s_waitcnt lgkmcnt(0)
    s_barrier
    ds_read_b64 v[108:109], v1
    v_lshrrev_b32 v112, 6, v0
    v_lshlrev_b32 v113, 2, v112
    v_add_u32 v113, 16384, v113
    s_waitcnt lgkmcnt(0)
    v_add_u32 v110, v108, v109
    v_mov_b32 v111, v110
    s_nop 1
    v_add_u32_dpp v111, v111, v111 row_shr:1 row_mask:0xf bank_mask:0xf
    s_nop 1
    v_add_u32_dpp v111, v111, v111 row_shr:2 row_mask:0xf bank_mask:0xf
    s_nop 1
    v_add_u32_dpp v111, v111, v111 row_shr:4 row_mask:0xf bank_mask:0xf
    s_nop 1
    v_add_u32_dpp v111, v111, v111 row_shr:8 row_mask:0xf bank_mask:0xf
    s_nop 1
    v_add_u32_dpp v111, v111, v111 row_bcast:15 row_mask:0xa bank_mask:0xf
    s_nop 1
    v_add_u32_dpp v111, v111, v111 row_bcast:31 row_mask:0xc bank_mask:0xf
    s_mov_b32 exec_lo, 0
    s_mov_b32 exec_hi, 0x80000000
    ds_write_b32 v113, v111
    s_mov_b64 exec, -1
    s_waitcnt lgkmcnt(0)
    s_barrier
    v_and_b32 v113, 15, v0
    v_lshlrev_b32 v114, 2, v113
    ds_read_b32 v114, v114 offset:16384
    v_cmp_lt_u32 vcc, v113, v112
    s_waitcnt lgkmcnt(0)
    s_nop 0
    v_cndmask_b32 v114, 0, v114, vcc
    s_nop 1
    v_add_u32_dpp v114, v114, v114 row_shr:1 row_mask:0xf bank_mask:0xf
    s_nop 1
    v_add_u32_dpp v114, v114, v114 row_shr:2 row_mask:0xf bank_mask:0xf
    s_nop 1
    v_add_u32_dpp v114, v114, v114 row_shr:4 row_mask:0xf bank_mask:0xf
    s_nop 1
    v_add_u32_dpp v114, v114, v114 row_shr:8 row_mask:0xf bank_mask:0xf
    s_nop 1
    v_readlane_b32 s3, v114, 15
    v_sub_u32 v111, v111, v110
    s_nop 0
    v_add_u32 v116, s3, v111
    v_add_u32 v117, v116, v108
    ds_write_b64 v1, v[116:117]
    v_lshl_or_b32 v118, v108, 16, v116
    v_lshl_or_b32 v119, v109, 16, v117
    buffer_store_dwordx2 v[118:119], v1, s[32:35], 0 offen
    s_waitcnt lgkmcnt(0)
    s_barrier
    ds_add_rtn_u32 v8, v8, v6
    ds_add_rtn_u32 v9, v9, v6
    ds_add_rtn_u32 v10, v10, v6
    ds_add_rtn_u32 v11, v11, v6
    ds_add_rtn_u32 v12, v12, v6
    ds_add_rtn_u32 v13, v13, v6
    ds_add_rtn_u32 v14, v14, v6
    ds_add_rtn_u32 v15, v15, v6
    ds_add_rtn_u32 v16, v16, v6
    ds_add_rtn_u32 v17, v17, v6
    ds_add_rtn_u32 v18, v18, v6
    ds_add_rtn_u32 v19, v19, v6
    ds_add_rtn_u32 v20, v20, v6
    ds_add_rtn_u32 v21, v21, v6
    ds_add_rtn_u32 v22, v22, v6
    ds_add_rtn_u32 v23, v23, v6
    ds_add_rtn_u32 v24, v24, v6
    ds_add_rtn_u32 v25, v25, v6
    ds_add_rtn_u32 v26, v26, v6
    ds_add_rtn_u32 v27, v27, v6
    ds_add_rtn_u32 v28, v28, v6
    ds_add_rtn_u32 v29, v29, v6
    ds_add_rtn_u32 v30, v30, v6
    ds_add_rtn_u32 v31, v31, v6
    ds_add_rtn_u32 v32, v32, v6
    ds_add_rtn_u32 v33, v33, v6
    ds_add_rtn_u32 v34, v34, v6
    ds_add_rtn_u32 v35, v35, v6
    ds_add_rtn_u32 v36, v36, v6
    ds_add_rtn_u32 v37, v37, v6
    ds_add_rtn_u32 v38, v38, v6
    ds_add_rtn_u32 v39, v39, v6
    ds_add_rtn_u32 v40, v40, v6
    ds_add_rtn_u32 v41, v41, v6
    ds_add_rtn_u32 v42, v42, v6
    ds_add_rtn_u32 v43, v43, v6
    ds_add_rtn_u32 v44, v44, v6
    ds_add_rtn_u32 v45, v45, v6
    ds_add_rtn_u32 v46, v46, v6
    ds_add_rtn_u32 v47, v47, v6
    s_waitcnt lgkmcnt(0)
    s_barrier
    v_lshlrev_b32 v108, 2, v8
    ds_write_b32 v108, v48
    v_lshlrev_b32 v109, 2, v9
    ds_write_b32 v109, v49
    v_lshlrev_b32 v108, 2, v10
    ds_write_b32 v108, v50
    v_lshlrev_b32 v109, 2, v11
    ds_write_b32 v109, v51
    v_lshlrev_b32 v108, 2, v12
    ds_write_b32 v108, v52
    v_lshlrev_b32 v109, 2, v13
    ds_write_b32 v109, v53
    v_lshlrev_b32 v108, 2, v14
    ds_write_b32 v108, v54
    v_lshlrev_b32 v109, 2, v15
    ds_write_b32 v109, v55
    v_lshlrev_b32 v108, 2, v16
    ds_write_b32 v108, v56
    v_lshlrev_b32 v109, 2, v17
    ds_write_b32 v109, v57
    v_lshlrev_b32 v108, 2, v18
    ds_write_b32 v108, v58
    v_lshlrev_b32 v109, 2, v19
    ds_write_b32 v109, v59
    v_lshlrev_b32 v108, 2, v20
    ds_write_b32 v108, v60
    v_lshlrev_b32 v109, 2, v21
    ds_write_b32 v109, v61
    v_lshlrev_b32 v108, 2, v22
    ds_write_b32 v108, v62
    v_lshlrev_b32 v109, 2, v23
    ds_write_b32 v109, v63
    v_lshlrev_b32 v108, 2, v24
    ds_write_b32 v108, v64
    v_lshlrev_b32 v109, 2, v25
    ds_write_b32 v109, v65
    v_lshlrev_b32 v108, 2, v26
    ds_write_b32 v108, v66
    v_lshlrev_b32 v109, 2, v27
    ds_write_b32 v109, v67
    v_lshlrev_b32 v108, 2, v28
    ds_write_b32 v108, v68
    v_lshlrev_b32 v109, 2, v29
    ds_write_b32 v109, v69
    v_lshlrev_b32 v108, 2, v30
    ds_write_b32 v108, v70
    v_lshlrev_b32 v109, 2, v31
    ds_write_b32 v109, v71
    v_lshlrev_b32 v108, 2, v32
    ds_write_b32 v108, v72
    v_lshlrev_b32 v109, 2, v33
    ds_write_b32 v109, v73
    v_lshlrev_b32 v108, 2, v34
    ds_write_b32 v108, v74
    v_lshlrev_b32 v109, 2, v35
    ds_write_b32 v109, v75
    v_lshlrev_b32 v108, 2, v36
    ds_write_b32 v108, v76
    v_lshlrev_b32 v109, 2, v37
    ds_write_b32 v109, v77
    v_lshlrev_b32 v108, 2, v38
    ds_write_b32 v108, v78
    v_lshlrev_b32 v109, 2, v39
    ds_write_b32 v109, v79
    v_lshlrev_b32 v108, 2, v40
    ds_write_b32 v108, v80
    v_lshlrev_b32 v109, 2, v41
    ds_write_b32 v109, v81
    v_lshlrev_b32 v108, 2, v42
    ds_write_b32 v108, v82
    v_lshlrev_b32 v109, 2, v43
    ds_write_b32 v109, v83
    v_lshlrev_b32 v108, 2, v44
    ds_write_b32 v108, v84
    v_lshlrev_b32 v109, 2, v45
    ds_write_b32 v109, v85
    v_lshlrev_b32 v108, 2, v46
    ds_write_b32 v108, v86
    v_lshlrev_b32 v109, 2, v47
    ds_write_b32 v109, v87
    s_waitcnt lgkmcnt(0)
    s_barrier
    v_add_u32 v5, 0x10000, v4
    v_add_u32 v7, 0x20000, v4
    ds_read_b128 v[48:51], v4 offset:0
    ds_read_b128 v[52:55], v4 offset:16384
    ds_read_b128 v[56:59], v4 offset:32768
    ds_read_b128 v[60:63], v4 offset:49152
    ds_read_b128 v[64:67], v5 offset:0
    ds_read_b128 v[68:71], v5 offset:16384
    ds_read_b128 v[72:75], v5 offset:32768
    ds_read_b128 v[76:79], v5 offset:49152
    ds_read_b128 v[80:83], v7 offset:0
    ds_read_b128 v[84:87], v7 offset:16384
    s_waitcnt lgkmcnt(9)
    buffer_store_dwordx4 v[48:51], v4, s[24:27], s40 offen
    s_waitcnt lgkmcnt(8)
    buffer_store_dwordx4 v[52:55], v4, s[24:27], s41 offen
    s_waitcnt lgkmcnt(7)
    buffer_store_dwordx4 v[56:59], v4, s[24:27], s42 offen
    s_waitcnt lgkmcnt(6)
    buffer_store_dwordx4 v[60:63], v4, s[24:27], s43 offen
    s_waitcnt lgkmcnt(5)
    buffer_store_dwordx4 v[64:67], v4, s[24:27], s44 offen
    s_waitcnt lgkmcnt(4)
    buffer_store_dwordx4 v[68:71], v4, s[24:27], s45 offen
    s_waitcnt lgkmcnt(3)
    buffer_store_dwordx4 v[72:75], v4, s[24:27], s46 offen
    s_waitcnt lgkmcnt(2)
    buffer_store_dwordx4 v[76:79], v4, s[24:27], s47 offen
    s_waitcnt lgkmcnt(1)
    buffer_store_dwordx4 v[80:83], v4, s[24:27], s48 offen
    s_waitcnt lgkmcnt(0)
    buffer_store_dwordx4 v[84:87], v4, s[24:27], s49 offen
    s_barrier
    v_lshlrev_b32 v108, 1, v8
    ds_write_b16 v108, v88
    v_lshlrev_b32 v109, 1, v9
    ds_write_b16_d16_hi v109, v88
    v_lshlrev_b32 v108, 1, v10
    ds_write_b16 v108, v89
    v_lshlrev_b32 v109, 1, v11
    ds_write_b16_d16_hi v109, v89
    v_lshlrev_b32 v108, 1, v12
    ds_write_b16 v108, v90
    v_lshlrev_b32 v109, 1, v13
    ds_write_b16_d16_hi v109, v90
    v_lshlrev_b32 v108, 1, v14
    ds_write_b16 v108, v91
    v_lshlrev_b32 v109, 1, v15
    ds_write_b16_d16_hi v109, v91
    v_lshlrev_b32 v108, 1, v16
    ds_write_b16 v108, v92
    v_lshlrev_b32 v109, 1, v17
    ds_write_b16_d16_hi v109, v92
    v_lshlrev_b32 v108, 1, v18
    ds_write_b16 v108, v93
    v_lshlrev_b32 v109, 1, v19
    ds_write_b16_d16_hi v109, v93
    v_lshlrev_b32 v108, 1, v20
    ds_write_b16 v108, v94
    v_lshlrev_b32 v109, 1, v21
    ds_write_b16_d16_hi v109, v94
    v_lshlrev_b32 v108, 1, v22
    ds_write_b16 v108, v95
    v_lshlrev_b32 v109, 1, v23
    ds_write_b16_d16_hi v109, v95
    v_lshlrev_b32 v108, 1, v24
    ds_write_b16 v108, v96
    v_lshlrev_b32 v109, 1, v25
    ds_write_b16_d16_hi v109, v96
    v_lshlrev_b32 v108, 1, v26
    ds_write_b16 v108, v97
    v_lshlrev_b32 v109, 1, v27
    ds_write_b16_d16_hi v109, v97
    v_lshlrev_b32 v108, 1, v28
    ds_write_b16 v108, v98
    v_lshlrev_b32 v109, 1, v29
    ds_write_b16_d16_hi v109, v98
    v_lshlrev_b32 v108, 1, v30
    ds_write_b16 v108, v99
    v_lshlrev_b32 v109, 1, v31
    ds_write_b16_d16_hi v109, v99
    v_lshlrev_b32 v108, 1, v32
    ds_write_b16 v108, v100
    v_lshlrev_b32 v109, 1, v33
    ds_write_b16_d16_hi v109, v100
    v_lshlrev_b32 v108, 1, v34
    ds_write_b16 v108, v101
    v_lshlrev_b32 v109, 1, v35
    ds_write_b16_d16_hi v109, v101
    v_lshlrev_b32 v108, 1, v36
    ds_write_b16 v108, v102
    v_lshlrev_b32 v109, 1, v37
    ds_write_b16_d16_hi v109, v102
    v_lshlrev_b32 v108, 1, v38
    ds_write_b16 v108, v103
    v_lshlrev_b32 v109, 1, v39
    ds_write_b16_d16_hi v109, v103
    v_lshlrev_b32 v108, 1, v40
    ds_write_b16 v108, v104
    v_lshlrev_b32 v109, 1, v41
    ds_write_b16_d16_hi v109, v104
    v_lshlrev_b32 v108, 1, v42
    ds_write_b16 v108, v105
    v_lshlrev_b32 v109, 1, v43
    ds_write_b16_d16_hi v109, v105
    v_lshlrev_b32 v108, 1, v44
    ds_write_b16 v108, v106
    v_lshlrev_b32 v109, 1, v45
    ds_write_b16_d16_hi v109, v106
    v_lshlrev_b32 v108, 1, v46
    ds_write_b16 v108, v107
    v_lshlrev_b32 v109, 1, v47
    ds_write_b16_d16_hi v109, v107
    s_waitcnt lgkmcnt(0)
    s_barrier
    ds_read_b128 v[8:11], v4 offset:0
    ds_read_b128 v[12:15], v4 offset:16384
    ds_read_b128 v[16:19], v4 offset:32768
    ds_read_b128 v[20:23], v4 offset:49152
    ds_read_b128 v[24:27], v5 offset:0
    s_waitcnt lgkmcnt(4)
    buffer_store_dwordx4 v[8:11], v4, s[28:31], s40 offen
    s_waitcnt lgkmcnt(3)
    buffer_store_dwordx4 v[12:15], v4, s[28:31], s41 offen
    s_waitcnt lgkmcnt(2)
    buffer_store_dwordx4 v[16:19], v4, s[28:31], s42 offen
    s_waitcnt lgkmcnt(1)
    buffer_store_dwordx4 v[20:23], v4, s[28:31], s43 offen
    s_waitcnt lgkmcnt(0)
    buffer_store_dwordx4 v[24:27], v4, s[28:31], s44 offen
k1_end:
    s_endpgm
.globl k2_kernel
.p2align 8
.type k2_kernel,@function
k2_kernel:
    s_cmp_ge_u32 s2, 250
    s_cbranch_scc1 k2_end
    s_mov_b32 s36, s2
    s_and_b32 s39, s2, 7
    s_lshr_b32 s40, s2, 3
    s_mul_i32 s36, s39, 31
    s_min_u32 s39, s39, 2
    s_add_u32 s36, s36, s39
    s_add_u32 s36, s36, s40
    s_load_dwordx2 s[64:65], s[0:1], 104
    s_load_dwordx2 s[52:53], s[0:1], 0
    s_load_dwordx2 s[66:67], s[0:1], 24
    s_load_dwordx2 s[68:69], s[0:1], 40
    s_load_dwordx4 s[72:75], s[0:1], 56
    s_load_dwordx4 s[76:79], s[0:1], 72
    v_lshrrev_b32 v100, 6, v0
    v_mov_b32 v104, v0
    v_and_b32 v101, 63, v0
    v_readfirstlane_b32 s35, v100
    v_and_b32 v102, 15, v101
    v_lshrrev_b32 v103, 4, v101
    v_mov_b32 v0, v101
    s_mul_i32 s48, s35, 5000
    s_lshl_b32 s40, s36, 2
    s_add_u32 s48, s48, s40
    s_cmp_lt_u32 s35, 10
    s_movk_i32 s50, 0x7fff
    s_cselect_b32 s50, 0xffff, s50
    s_mov_b32 s51, 0
    v_mov_b32 v107, 0
    v_mov_b32 v6, 0
    v_mul_u32_u24 v108, 80000, v101
    s_add_u32 s40, s48, 1000
    s_mul_i32 s39, s35, 1280
    s_add_u32 s39, s39, 129024
    s_mul_i32 s41, s35, 800
    s_add_u32 s41, s41, 12800
    s_waitcnt lgkmcnt(0)
    s_add_u32 s54, s64, 61440000
    s_addc_u32 s55, s65, 0
    s_mov_b32 s56, s54
    s_mov_b32 s57, s55
    s_mov_b32 s58, 1250000
    s_mov_b32 s59, 0x00020000
    s_mov_b64 exec, s[50:51]
    buffer_load_dword v107, v108, s[56:59], s48 offen
    buffer_load_dword v6, v108, s[56:59], s40 offen
    s_mov_b64 exec, -1
    s_mov_b32 s84, s76
    s_mov_b32 s85, s77
    s_mov_b32 s86, 512
    s_mov_b32 s87, 0x00020000
    v_and_b32 v111, 1, v103
    v_lshlrev_b32 v111, 8, v111
    v_lshl_add_u32 v111, v102, 1, v111
    buffer_load_ushort v112, v111, s[84:87], 0 offen offset:0
    buffer_load_ushort v113, v111, s[84:87], 0 offen offset:32
    buffer_load_ushort v114, v111, s[84:87], 0 offen offset:64
    buffer_load_ushort v115, v111, s[84:87], 0 offen offset:96
    buffer_load_ushort v116, v111, s[84:87], 0 offen offset:128
    buffer_load_ushort v117, v111, s[84:87], 0 offen offset:160
    buffer_load_ushort v118, v111, s[84:87], 0 offen offset:192
    buffer_load_ushort v119, v111, s[84:87], 0 offen offset:224
    s_mov_b32 s92, s66
    s_mov_b32 s93, s67
    s_mov_b32 s94, 640000
    s_mov_b32 s95, 0x00020000
    v_lshlrev_b32 v109, 2, v104
    s_mul_i32 s40, s36, 2560
    v_cmp_gt_u32 vcc, 640, v104
    s_and_saveexec_b64 s[96:97], vcc
    buffer_load_dword v120, v109, s[92:95], s40 offen
    s_mov_b64 exec, s[96:97]
    s_cmp_lt_u32 s35, 3
    s_cselect_b32 s88, s74, s68
    s_cselect_b32 s89, s75, s69
    s_cselect_b32 s90, 768, 16
    s_cselect_b32 s80, 384, 8
    s_cselect_b32 s81, 2, 0
    s_cselect_b32 s82, 96, 2
    s_cselect_b32 s83, s35, 0
    s_lshl_b32 s83, s83, 5
    s_sub_u32 s40, s35, 3
    s_cmp_lt_u32 s40, 2
    s_cselect_b32 s80, 128, s80
    s_cselect_b32 s81, 2, s81
    s_cselect_b32 s82, 32, s82
    s_cmp_eq_u32 s35, 3
    s_cselect_b32 s88, s72, s88
    s_cselect_b32 s89, s73, s89
    s_cselect_b32 s90, 256, s90
    s_cmp_eq_u32 s35, 4
    s_cselect_b32 s88, s78, s88
    s_cselect_b32 s89, s79, s89
    s_cselect_b32 s90, 512, s90
    s_mov_b32 s91, 0x00020000
    v_mul_u32_u24 v105, s80, v103
    v_mad_u32_u24 v105, v102, s81, v105
    v_add_u32 v105, s83, v105
    s_lshl_b32 s83, s82, 1
    s_add_u32 s40, s83, s82
    buffer_load_ushort v60, v105, s[88:91], 0 offen
    buffer_load_ushort v61, v105, s[88:91], s82 offen
    buffer_load_ushort v62, v105, s[88:91], s83 offen
    buffer_load_ushort v63, v105, s[88:91], s40 offen
    s_sub_u32 s80, s64, s39
    s_subb_u32 s81, s65, 0
    s_mov_b32 s8, s80
    s_mov_b32 s9, s81
    s_mov_b32 s10, 41115648
    s_mov_b32 s11, 0x00020000
    s_add_u32 s80, s64, 40960000
    s_addc_u32 s81, s65, 0
    s_sub_u32 s80, s80, s41
    s_subb_u32 s81, s81, 0
    s_mov_b32 s12, s80
    s_mov_b32 s13, s81
    s_mov_b32 s14, 20635648
    s_mov_b32 s15, 0x00020000
    v_lshl_add_u32 v1, v101, 2, s39
    v_lshl_add_u32 v2, v103, 4, s39
    v_lshl_add_u32 v3, v101, 1, s41
    s_lshl_b32 s31, s41, 2
    v_lshrrev_b32 v105, 2, v102
    v_lshlrev_b32 v105, 3, v105
    v_and_b32 v106, 3, v102
    v_add_u32 v105, v105, v106
    v_lshrrev_b32 v106, 5, v101
    v_lshl_add_u32 v105, v106, 2, v105
    v_lshl_add_u32 v4, v105, 2, s31
    v_and_b32 v5, 16, v101
    s_mov_b32 s32, 4294916096
    s_mov_b32 s33, 0
    s_mul_i32 s44, s35, 20
    s_mov_b32 s49, s44
    s_mov_b32 s34, -1
    s_mov_b32 s37, 0
    s_mov_b32 s43, 0x8000
    s_mul_i32 s47, s35, 40960
    s_lshr_b32 s60, s35, 2
    v_mov_b32 v110, 0
    v_cmp_gt_u32 vcc, 176, v104
    s_and_saveexec_b64 s[96:97], vcc
    ds_write_b32 v109, v110
    s_mov_b64 exec, s[96:97]
    v_mov_b32 v64, 0x10101010
    v_mov_b32 v65, 0x10101010
    v_mov_b32 v66, 0x10101010
    v_mov_b32 v67, 0x10101010
    v_lshlrev_b32 v106, 4, v104
    ds_write_b128 v106, v[64:67] offset:1024
    v_cmp_gt_u32 vcc, 576, v104
    s_and_saveexec_b64 s[96:97], vcc
    ds_write_b128 v106, v[64:67] offset:17408
    s_mov_b64 exec, s[96:97]
    s_waitcnt vmcnt(13)
    v_lshrrev_b32 v105, 16, v107
    v_and_b32 v107, 0xffff, v107
    v_mul_u32_u24 v106, 655360, v0
    v_cmp_lt_u32 vcc, 63, v105
    v_add_u32 v107, v107, v106
    v_min_u32 v105, 63, v105
    v_add_u32 v107, s47, v107
    s_mov_b32 s61, vcc_lo
    v_lshl_or_b32 v107, v107, 7, v105
    s_nop 0
    v_readlane_b32 s39, v107, 0
    s_bfm_b64 s[64:65], s39, 0
    s_lshr_b32 s40, s39, 6
    s_mov_b64 exec, s[64:65]
    s_lshl_b32 s41, s40, 1
    buffer_load_ushort v44, v3, s[12:15], s40 offen
    buffer_load_dword v28, v1, s[8:11], s41 offen
    s_mov_b64 exec, -1
    v_readlane_b32 s39, v107, 1
    s_bfm_b64 s[66:67], s39, 0
    s_lshr_b32 s40, s39, 6
    s_mov_b64 exec, s[66:67]
    s_lshl_b32 s41, s40, 1
    buffer_load_ushort v45, v3, s[12:15], s40 offen
    buffer_load_dword v29, v1, s[8:11], s41 offen
    s_mov_b64 exec, -1
    v_readlane_b32 s39, v107, 2
    s_bfm_b64 s[68:69], s39, 0
    s_lshr_b32 s40, s39, 6
    s_mov_b64 exec, s[68:69]
    s_lshl_b32 s41, s40, 1
    buffer_load_ushort v46, v3, s[12:15], s40 offen
    buffer_load_dword v30, v1, s[8:11], s41 offen
    s_mov_b64 exec, -1
    v_readlane_b32 s39, v107, 3
    s_bfm_b64 s[70:71], s39, 0
    s_lshr_b32 s40, s39, 6
    s_mov_b64 exec, s[70:71]
    s_lshl_b32 s41, s40, 1
    buffer_load_ushort v47, v3, s[12:15], s40 offen
    buffer_load_dword v31, v1, s[8:11], s41 offen
    s_mov_b64 exec, -1
    v_readlane_b32 s39, v107, 4
    s_bfm_b64 s[72:73], s39, 0
    s_lshr_b32 s40, s39, 6
    s_mov_b64 exec, s[72:73]
    s_lshl_b32 s41, s40, 1
    buffer_load_ushort v48, v3, s[12:15], s40 offen
    buffer_load_dword v32, v1, s[8:11], s41 offen
    s_mov_b64 exec, -1
    v_readlane_b32 s39, v107, 5
    s_bfm_b64 s[74:75], s39, 0
    s_lshr_b32 s40, s39, 6
    s_mov_b64 exec, s[74:75]
    s_lshl_b32 s41, s40, 1
    buffer_load_ushort v49, v3, s[12:15], s40 offen
    buffer_load_dword v33, v1, s[8:11], s41 offen
    s_mov_b64 exec, -1
    v_readlane_b32 s39, v107, 6
    s_bfm_b64 s[76:77], s39, 0
    s_lshr_b32 s40, s39, 6
    s_mov_b64 exec, s[76:77]
    s_lshl_b32 s41, s40, 1
    buffer_load_ushort v50, v3, s[12:15], s40 offen
    buffer_load_dword v34, v1, s[8:11], s41 offen
    s_mov_b64 exec, -1
    v_readlane_b32 s39, v107, 7
    s_bfm_b64 s[78:79], s39, 0
    s_lshr_b32 s40, s39, 6
    s_mov_b64 exec, s[78:79]
    s_lshl_b32 s41, s40, 1
    buffer_load_ushort v51, v3, s[12:15], s40 offen
    buffer_load_dword v35, v1, s[8:11], s41 offen
    s_mov_b64 exec, -1
    v_readlane_b32 s39, v107, 8
    s_bfm_b64 s[80:81], s39, 0
    s_lshr_b32 s40, s39, 6
    s_mov_b64 exec, s[80:81]
    s_lshl_b32 s41, s40, 1
    buffer_load_ushort v52, v3, s[12:15], s40 offen
    buffer_load_dword v36, v1, s[8:11], s41 offen
    s_mov_b64 exec, -1
    v_readlane_b32 s39, v107, 9
    s_bfm_b64 s[82:83], s39, 0
    s_lshr_b32 s40, s39, 6
    s_mov_b64 exec, s[82:83]
    s_lshl_b32 s41, s40, 1
    buffer_load_ushort v53, v3, s[12:15], s40 offen
    buffer_load_dword v37, v1, s[8:11], s41 offen
    s_mov_b64 exec, -1
    v_readlane_b32 s39, v107, 10
    s_bfm_b64 s[84:85], s39, 0
    s_lshr_b32 s40, s39, 6
    s_mov_b64 exec, s[84:85]
    s_lshl_b32 s41, s40, 1
    buffer_load_ushort v54, v3, s[12:15], s40 offen
    buffer_load_dword v38, v1, s[8:11], s41 offen
    s_mov_b64 exec, -1
    v_readlane_b32 s39, v107, 11
    s_bfm_b64 s[86:87], s39, 0
    s_lshr_b32 s40, s39, 6
    s_mov_b64 exec, s[86:87]
    s_lshl_b32 s41, s40, 1
    buffer_load_ushort v55, v3, s[12:15], s40 offen
    buffer_load_dword v39, v1, s[8:11], s41 offen
    s_mov_b64 exec, -1
    v_readlane_b32 s39, v107, 12
    s_bfm_b64 s[88:89], s39, 0
    s_lshr_b32 s40, s39, 6
    s_mov_b64 exec, s[88:89]
    s_lshl_b32 s41, s40, 1
    buffer_load_ushort v56, v3, s[12:15], s40 offen
    buffer_load_dword v40, v1, s[8:11], s41 offen
    s_mov_b64 exec, -1
    v_readlane_b32 s39, v107, 13
    s_bfm_b64 s[90:91], s39, 0
    s_lshr_b32 s40, s39, 6
    s_mov_b64 exec, s[90:91]
    s_lshl_b32 s41, s40, 1
    buffer_load_ushort v57, v3, s[12:15], s40 offen
    buffer_load_dword v41, v1, s[8:11], s41 offen
    s_mov_b64 exec, -1
    v_readlane_b32 s39, v107, 14
    s_bfm_b64 s[92:93], s39, 0
    s_lshr_b32 s40, s39, 6
    s_mov_b64 exec, s[92:93]
    s_lshl_b32 s41, s40, 1
    buffer_load_ushort v58, v3, s[12:15], s40 offen
    buffer_load_dword v42, v1, s[8:11], s41 offen
    s_mov_b64 exec, -1
    v_readlane_b32 s39, v107, 15
    s_bfm_b64 s[94:95], s39, 0
    s_lshr_b32 s40, s39, 6
    s_mov_b64 exec, s[94:95]
    s_lshl_b32 s41, s40, 1
    buffer_load_ushort v59, v3, s[12:15], s40 offen
    buffer_load_dword v43, v1, s[8:11], s41 offen
    s_mov_b64 exec, -1
    s_waitcnt vmcnt(32) lgkmcnt(0)
    s_barrier
    v_cmp_gt_u32 vcc, 640, v104
    s_and_saveexec_b64 s[98:99], vcc
    v_add_u32 v121, 153088, v109
    ds_write_b32 v121, v120
    s_mov_b64 exec, s[98:99]
    v_lshl_or_b32 v112, v113, 16, v112
    v_lshl_or_b32 v114, v115, 16, v114
    v_lshl_or_b32 v116, v117, 16, v116
    v_lshl_or_b32 v118, v119, 16, v118
    v_cmp_gt_u32 vcc, 32, v101
    s_nop 1
    v_cndmask_b32 v20, 0, v112, vcc
    v_cndmask_b32 v21, 0, v114, vcc
    v_cndmask_b32 v22, 0, v116, vcc
    v_cndmask_b32 v23, 0, v118, vcc
    v_cmp_le_u32 vcc, 32, v101
    s_nop 1
    v_cndmask_b32 v24, 0, v112, vcc
    v_cndmask_b32 v25, 0, v114, vcc
    v_cndmask_b32 v26, 0, v116, vcc
    v_cndmask_b32 v27, 0, v118, vcc
    s_cmp_gt_u32 s35, 5
    s_cbranch_scc1 k2_noepi
    s_cmp_eq_u32 s35, 5
    s_cbranch_scc1 k2_epicen
    s_lshl_b32 s40, s35, 9
    s_add_u32 s40, s40, 149504
    v_lshl_add_u32 v105, v101, 3, s40
    v_lshl_or_b32 v60, v61, 16, v60
    v_lshl_or_b32 v61, v63, 16, v62
    ds_write_b64 v105, v[60:61]
    s_branch k2_noepi
k2_epicen:
    v_lshlrev_b32 v106, 4, v101
    v_add_u32 v106, 152064, v106
    v_lshlrev_b32 v60, 16, v60
    v_lshlrev_b32 v61, 16, v61
    v_lshlrev_b32 v62, 16, v62
    v_lshlrev_b32 v63, 16, v63
    ds_write_b128 v106, v[60:63]
k2_noepi:
    s_waitcnt vmcnt(30)
    s_mov_b64 exec, s[64:65]
    v_bfe_u32 v68, v44, 4, 12
    ds_inc_rtn_u32 v84, v68, v1 offset:0
    s_waitcnt vmcnt(28)
    s_mov_b64 exec, s[66:67]
    v_bfe_u32 v69, v45, 4, 12
    ds_inc_rtn_u32 v85, v69, v1 offset:0
    s_waitcnt vmcnt(26)
    s_mov_b64 exec, s[68:69]
    v_bfe_u32 v70, v46, 4, 12
    ds_inc_rtn_u32 v86, v70, v1 offset:0
    s_waitcnt vmcnt(24)
    s_mov_b64 exec, s[70:71]
    v_bfe_u32 v71, v47, 4, 12
    ds_inc_rtn_u32 v87, v71, v1 offset:0
    s_waitcnt vmcnt(22)
    s_mov_b64 exec, s[72:73]
    v_bfe_u32 v72, v48, 4, 12
    ds_inc_rtn_u32 v88, v72, v1 offset:0
    s_waitcnt vmcnt(20)
    s_mov_b64 exec, s[74:75]
    v_bfe_u32 v73, v49, 4, 12
    ds_inc_rtn_u32 v89, v73, v1 offset:0
    s_waitcnt vmcnt(18)
    s_mov_b64 exec, s[76:77]
    v_bfe_u32 v74, v50, 4, 12
    ds_inc_rtn_u32 v90, v74, v1 offset:0
    s_waitcnt vmcnt(16)
    s_mov_b64 exec, s[78:79]
    v_bfe_u32 v75, v51, 4, 12
    ds_inc_rtn_u32 v91, v75, v1 offset:0
    s_waitcnt vmcnt(14)
    s_mov_b64 exec, s[80:81]
    v_bfe_u32 v76, v52, 4, 12
    ds_inc_rtn_u32 v92, v76, v1 offset:0
    s_waitcnt vmcnt(12)
    s_mov_b64 exec, s[82:83]
    v_bfe_u32 v77, v53, 4, 12
    ds_inc_rtn_u32 v93, v77, v1 offset:0
    s_waitcnt vmcnt(10)
    s_mov_b64 exec, s[84:85]
    v_bfe_u32 v78, v54, 4, 12
    ds_inc_rtn_u32 v94, v78, v1 offset:0
    s_waitcnt vmcnt(8)
    s_mov_b64 exec, s[86:87]
    v_bfe_u32 v79, v55, 4, 12
    ds_inc_rtn_u32 v95, v79, v1 offset:0
    s_waitcnt vmcnt(6)
    s_mov_b64 exec, s[88:89]
    v_bfe_u32 v80, v56, 4, 12
    ds_inc_rtn_u32 v96, v80, v1 offset:0
    s_waitcnt vmcnt(4)
    s_mov_b64 exec, s[90:91]
    v_bfe_u32 v81, v57, 4, 12
    ds_inc_rtn_u32 v97, v81, v1 offset:0
    s_waitcnt vmcnt(2)
    s_mov_b64 exec, s[92:93]
    v_bfe_u32 v82, v58, 4, 12
    ds_inc_rtn_u32 v98, v82, v1 offset:0
    s_waitcnt vmcnt(0)
    s_mov_b64 exec, s[94:95]
    v_bfe_u32 v83, v59, 4, 12
    ds_inc_rtn_u32 v99, v83, v1 offset:0
    s_waitcnt lgkmcnt(12)
    s_mov_b64 exec, s[64:65]
    v_min_u32 v84, 159, v84
    v_mad_u32_u24 v84, v68, 40, v84
    ds_write_b8 v84, v44 offset:1024
    v_lshlrev_b32 v84, 2, v84
    ds_write_b32 v84, v28 offset:26624
    s_mov_b64 exec, s[66:67]
    v_min_u32 v85, 159, v85
    v_mad_u32_u24 v85, v69, 40, v85
    ds_write_b8 v85, v45 offset:1024
    v_lshlrev_b32 v85, 2, v85
    ds_write_b32 v85, v29 offset:26624
    s_mov_b64 exec, s[68:69]
    v_min_u32 v86, 159, v86
    v_mad_u32_u24 v86, v70, 40, v86
    ds_write_b8 v86, v46 offset:1024
    v_lshlrev_b32 v86, 2, v86
    ds_write_b32 v86, v30 offset:26624
    s_mov_b64 exec, s[70:71]
    v_min_u32 v87, 159, v87
    v_mad_u32_u24 v87, v71, 40, v87
    ds_write_b8 v87, v47 offset:1024
    v_lshlrev_b32 v87, 2, v87
    ds_write_b32 v87, v31 offset:26624
    s_waitcnt lgkmcnt(8)
    s_mov_b64 exec, s[72:73]
    v_min_u32 v88, 159, v88
    v_mad_u32_u24 v88, v72, 40, v88
    ds_write_b8 v88, v48 offset:1024
    v_lshlrev_b32 v88, 2, v88
    ds_write_b32 v88, v32 offset:26624
    s_mov_b64 exec, s[74:75]
    v_min_u32 v89, 159, v89
    v_mad_u32_u24 v89, v73, 40, v89
    ds_write_b8 v89, v49 offset:1024
    v_lshlrev_b32 v89, 2, v89
    ds_write_b32 v89, v33 offset:26624
    s_mov_b64 exec, s[76:77]
    v_min_u32 v90, 159, v90
    v_mad_u32_u24 v90, v74, 40, v90
    ds_write_b8 v90, v50 offset:1024
    v_lshlrev_b32 v90, 2, v90
    ds_write_b32 v90, v34 offset:26624
    s_mov_b64 exec, s[78:79]
    v_min_u32 v91, 159, v91
    v_mad_u32_u24 v91, v75, 40, v91
    ds_write_b8 v91, v51 offset:1024
    v_lshlrev_b32 v91, 2, v91
    ds_write_b32 v91, v35 offset:26624
    s_mov_b64 exec, s[80:81]
    v_min_u32 v92, 159, v92
    v_mad_u32_u24 v92, v76, 40, v92
    ds_write_b8 v92, v52 offset:1024
    v_lshlrev_b32 v92, 2, v92
    ds_write_b32 v92, v36 offset:26624
    s_mov_b64 exec, s[82:83]
    v_min_u32 v93, 159, v93
    v_mad_u32_u24 v93, v77, 40, v93
    ds_write_b8 v93, v53 offset:1024
    v_lshlrev_b32 v93, 2, v93
    ds_write_b32 v93, v37 offset:26624
    s_mov_b64 exec, s[84:85]
    v_min_u32 v94, 159, v94
    v_mad_u32_u24 v94, v78, 40, v94
    ds_write_b8 v94, v54 offset:1024
    v_lshlrev_b32 v94, 2, v94
    ds_write_b32 v94, v38 offset:26624
    s_mov_b64 exec, s[86:87]
    v_min_u32 v95, 159, v95
    v_mad_u32_u24 v95, v79, 40, v95
    ds_write_b8 v95, v55 offset:1024
    v_lshlrev_b32 v95, 2, v95
    ds_write_b32 v95, v39 offset:26624
    s_mov_b64 exec, s[88:89]
    v_min_u32 v96, 159, v96
    v_mad_u32_u24 v96, v80, 40, v96
    ds_write_b8 v96, v56 offset:1024
    v_lshlrev_b32 v96, 2, v96
    ds_write_b32 v96, v40 offset:26624
    s_mov_b64 exec, s[90:91]
    v_min_u32 v97, 159, v97
    v_mad_u32_u24 v97, v81, 40, v97
    ds_write_b8 v97, v57 offset:1024
    v_lshlrev_b32 v97, 2, v97
    ds_write_b32 v97, v41 offset:26624
    s_mov_b64 exec, s[92:93]
    v_min_u32 v98, 159, v98
    v_mad_u32_u24 v98, v82, 40, v98
    ds_write_b8 v98, v58 offset:1024
    v_lshlrev_b32 v98, 2, v98
    ds_write_b32 v98, v42 offset:26624
    s_mov_b64 exec, s[94:95]
    v_min_u32 v99, 159, v99
    v_mad_u32_u24 v99, v83, 40, v99
    ds_write_b8 v99, v59 offset:1024
    v_lshlrev_b32 v99, 2, v99
    ds_write_b32 v99, v43 offset:26624
    s_mov_b64 exec, -1
    s_mov_b32 s38, s61
    s_cmp_eq_u32 s38, 0
    s_cbranch_scc0 k2_lc1
k2_lc_end1:
    v_mov_b32 v28, 0
    v_mov_b32 v29, 0
    v_mov_b32 v30, 0
    v_mov_b32 v31, 0
    v_mov_b32 v32, 0
    v_mov_b32 v33, 0
    v_mov_b32 v34, 0
    v_mov_b32 v35, 0
    v_mov_b32 v36, 0
    v_mov_b32 v37, 0
    v_mov_b32 v38, 0
    v_mov_b32 v39, 0
    v_mov_b32 v40, 0
    v_mov_b32 v41, 0
    v_mov_b32 v42, 0
    v_mov_b32 v43, 0
    v_mov_b32 v44, 0
    v_mov_b32 v45, 0
    v_mov_b32 v46, 0
    v_mov_b32 v47, 0
    v_mov_b32 v68, 0
    v_mov_b32 v69, 0
    v_mov_b32 v70, 0
    v_mov_b32 v71, 0
    v_mov_b32 v72, 0
    v_mov_b32 v73, 0
    v_mov_b32 v74, 0
    v_mov_b32 v75, 0
    v_mov_b32 v76, 0
    v_mov_b32 v77, 0
    v_mov_b32 v78, 0
    v_mov_b32 v79, 0
    v_mov_b32 v80, 0
    v_mov_b32 v81, 0
    v_mov_b32 v82, 0
    v_mov_b32 v83, 0
    v_mov_b32 v84, 0
    v_mov_b32 v85, 0
    v_mov_b32 v86, 0
    v_mov_b32 v87, 0
    v_mov_b32 v88, 0
    v_mov_b32 v89, 0
    v_mov_b32 v90, 0
    v_mov_b32 v91, 0
    v_mov_b32 v92, 0
    v_mov_b32 v93, 0
    v_mov_b32 v94, 0
    v_mov_b32 v95, 0
    v_mov_b32 v96, 0
    v_mov_b32 v97, 0
    v_mov_b32 v98, 0
    v_mov_b32 v99, 0
    v_mov_b32 v100, 0
    v_mov_b32 v101, 0
    v_mov_b32 v102, 0
    v_mov_b32 v103, 0
    v_mov_b32 v104, 0
    v_mov_b32 v105, 0
    v_mov_b32 v106, 0
    v_mov_b32 v107, 0
    v_mov_b32 v108, 0
    v_mov_b32 v109, 0
    v_mov_b32 v110, 0
    v_mov_b32 v111, 0
    v_mov_b32 v112, 0
    v_mov_b32 v113, 0
    v_mov_b32 v114, 0
    v_mov_b32 v115, 0
    v_mov_b32 v116, 0
    v_mov_b32 v117, 0
    v_mov_b32 v118, 0
    v_mov_b32 v119, 0
    v_mov_b32 v120, 0
    v_mov_b32 v121, 0
    v_mov_b32 v122, 0
    v_mov_b32 v123, 0
    v_mov_b32 v124, 0
    v_mov_b32 v125, 0
    v_mov_b32 v126, 0
    v_mov_b32 v127, 0
    s_mov_b32 s16, 0
    s_mov_b32 s17, 0
    s_mov_b32 s18, 0
    s_mov_b32 s19, 0
    s_mov_b32 s20, 0
    s_sub_u32 s52, s52, 2097152
    s_subb_u32 s53, s53, 0
    s_mov_b32 s7, 0x00020000
    s_waitcnt lgkmcnt(0)
    s_barrier
    s_branch k2_entry
k2_loop:
    s_waitcnt vmcnt(12)
    s_add_u32 s60, s60, 1
    s_and_b32 s60, s60, 3
    s_cmp_lt_u32 s60, 2
    s_cbranch_scc1 k2_pr01_2
    s_cmp_eq_u32 s60, 2
    s_cbranch_scc1 k2_pr2_2
    s_setprio 3
    s_branch k2_prd_2
k2_pr2_2:
    s_setprio 2
    s_branch k2_prd_2
k2_pr01_2:
    s_cmp_eq_u32 s60, 0
    s_cbranch_scc1 k2_pr0_2
    s_setprio 1
    s_branch k2_prd_2
k2_pr0_2:
    s_setprio 0
k2_prd_2:
    s_mov_b64 exec, s[66:67]
    v_bfe_u32 v17, v12, 4, 12
    ds_inc_rtn_u32 v18, v17, v1 offset:0
    s_mov_b64 exec, -1
    s_cmp_le_u32 s16, 0
    s_cbranch_scc1 k2_skip3
    v_mfma_f32_16x16x32_bf16 v[60:63], v[28:31], v[20:23], 0
    v_mfma_f32_16x16x32_bf16 v[64:67], v[28:31], v[24:27], 0
    ds_read_b128 v[28:31], v2 offset:640
    s_waitcnt lgkmcnt(4)
    v_pk_lshlrev_b16 v48, v0, v48 op_sel_hi:[0,1]
    v_pk_lshlrev_b16 v49, v0, v49 op_sel_hi:[0,1]
    v_pk_lshlrev_b16 v50, v0, v50 op_sel_hi:[0,1]
    v_pk_lshlrev_b16 v51, v0, v51 op_sel_hi:[0,1]
    v_pk_ashrrev_i16 v48, 15, v48 op_sel_hi:[0,1]
    v_pk_ashrrev_i16 v49, 15, v49 op_sel_hi:[0,1]
    v_pk_ashrrev_i16 v50, 15, v50 op_sel_hi:[0,1]
    v_pk_ashrrev_i16 v51, 15, v51 op_sel_hi:[0,1]
    s_nop 1
    v_cvt_pk_bf16_f32 v60, v60, v61
    v_cvt_pk_bf16_f32 v61, v62, v63
    v_cvt_pk_bf16_f32 v62, v64, v65
    v_cvt_pk_bf16_f32 v63, v66, v67
    s_waitcnt lgkmcnt(2)
    v_and_b32 v52, v48, v52
    v_and_b32 v53, v49, v53
    v_and_b32 v54, v50, v54
    v_and_b32 v55, v51, v55
    v_and_b32 v56, v48, v56
    v_and_b32 v57, v49, v57
    v_and_b32 v58, v50, v58
    v_and_b32 v59, v51, v59
    v_mfma_f32_16x16x32_bf16 v[68:71], v[60:63], v[52:55], v[68:71]
    s_waitcnt lgkmcnt(0)
    v_and_b32 v28, v48, v28
    v_mfma_f32_16x16x32_bf16 v[72:75], v[60:63], v[56:59], v[72:75]
    v_and_b32 v29, v49, v29
    v_and_b32 v30, v50, v30
    v_and_b32 v31, v51, v31
    s_nop 1
    v_mfma_f32_16x16x32_bf16 v[76:79], v[60:63], v[28:31], v[76:79]
k2_skip3:
    s_waitcnt lgkmcnt(0)
    s_mov_b64 exec, s[66:67]
    v_min_u32 v18, 159, v18
    v_mad_u32_u24 v18, v17, 40, v18
    ds_write_b8 v18, v12 offset:1024
    v_lshlrev_b32 v18, 2, v18
    ds_write_b32 v18, v7 offset:26624
    s_mov_b64 exec, -1
    s_lshl2_add_u32 s42, s17, s31
    v_cmp_gt_i32 vcc, s42, v4
    v_lshl_add_u32 v19, v19, 5, v5
    s_mov_b64 exec, vcc
    buffer_load_dwordx4 v[28:31], v19, s[4:7], 0 offen
    s_mov_b64 exec, -1
    ds_read_u16 v19, v4 offset:27392
    ds_read_b128 v[48:51], v2 offset:1024
    ds_read_b128 v[52:55], v2 offset:64
    ds_read_b128 v[56:59], v2 offset:384
    v_readlane_b32 s39, v6, 5
    s_bfm_b64 s[66:67], s39, 0
    s_lshr_b32 s40, s39, 6
    s_mov_b64 exec, s[66:67]
    s_lshl_b32 s41, s40, 1
    buffer_load_ushort v12, v3, s[12:15], s40 offen
    buffer_load_dword v7, v1, s[8:11], s41 offen
    s_mov_b64 exec, -1
    s_waitcnt vmcnt(12)
    s_mov_b64 exec, s[68:69]
    v_bfe_u32 v17, v13, 4, 12
    ds_inc_rtn_u32 v18, v17, v1 offset:0
    s_mov_b64 exec, -1
    s_cmp_le_u32 s16, 32
    s_cbranch_scc1 k2_skip4
    v_mfma_f32_16x16x32_bf16 v[60:63], v[32:35], v[20:23], 0
    v_mfma_f32_16x16x32_bf16 v[64:67], v[32:35], v[24:27], 0
    ds_read_b128 v[32:35], v2 offset:704
    s_waitcnt lgkmcnt(4)
    v_pk_lshlrev_b16 v48, v0, v48 op_sel_hi:[0,1]
    v_pk_lshlrev_b16 v49, v0, v49 op_sel_hi:[0,1]
    v_pk_lshlrev_b16 v50, v0, v50 op_sel_hi:[0,1]
    v_pk_lshlrev_b16 v51, v0, v51 op_sel_hi:[0,1]
    v_pk_ashrrev_i16 v48, 15, v48 op_sel_hi:[0,1]
    v_pk_ashrrev_i16 v49, 15, v49 op_sel_hi:[0,1]
    v_pk_ashrrev_i16 v50, 15, v50 op_sel_hi:[0,1]
    v_pk_ashrrev_i16 v51, 15, v51 op_sel_hi:[0,1]
    s_nop 1
    v_cvt_pk_bf16_f32 v60, v60, v61
    v_cvt_pk_bf16_f32 v61, v62, v63
    v_cvt_pk_bf16_f32 v62, v64, v65
    v_cvt_pk_bf16_f32 v63, v66, v67
    s_waitcnt lgkmcnt(2)
    v_and_b32 v52, v48, v52
    v_and_b32 v53, v49, v53
    v_and_b32 v54, v50, v54
    v_and_b32 v55, v51, v55
    v_and_b32 v56, v48, v56
    v_and_b32 v57, v49, v57
    v_and_b32 v58, v50, v58
    v_and_b32 v59, v51, v59
    v_mfma_f32_16x16x32_bf16 v[68:71], v[60:63], v[52:55], v[68:71]
    s_waitcnt lgkmcnt(0)
    v_and_b32 v32, v48, v32
    v_mfma_f32_16x16x32_bf16 v[72:75], v[60:63], v[56:59], v[72:75]
    v_and_b32 v33, v49, v33
    v_and_b32 v34, v50, v34
    v_and_b32 v35, v51, v35
    s_nop 1
    v_mfma_f32_16x16x32_bf16 v[76:79], v[60:63], v[32:35], v[76:79]
k2_skip4:
    s_waitcnt lgkmcnt(0)
    s_mov_b64 exec, s[68:69]
    v_min_u32 v18, 159, v18
    v_mad_u32_u24 v18, v17, 40, v18
    ds_write_b8 v18, v13 offset:1024
    v_lshlrev_b32 v18, 2, v18
    ds_write_b32 v18, v8 offset:26624
    s_mov_b64 exec, -1
    s_sub_u32 s42, s42, 128
    v_cmp_gt_i32 vcc, s42, v4
    v_lshl_add_u32 v19, v19, 5, v5
    s_mov_b64 exec, vcc
    buffer_load_dwordx4 v[32:35], v19, s[4:7], 0 offen
    s_mov_b64 exec, -1
    ds_read_u16 v19, v4 offset:27520
    ds_read_b128 v[48:51], v2 offset:1088
    ds_read_b128 v[52:55], v2 offset:128
    ds_read_b128 v[56:59], v2 offset:448
    v_readlane_b32 s39, v6, 6
    s_bfm_b64 s[68:69], s39, 0
    s_lshr_b32 s40, s39, 6
    s_mov_b64 exec, s[68:69]
    s_lshl_b32 s41, s40, 1
    buffer_load_ushort v13, v3, s[12:15], s40 offen
    buffer_load_dword v8, v1, s[8:11], s41 offen
    s_mov_b64 exec, -1
    s_waitcnt vmcnt(12)
    s_add_u32 s60, s60, 1
    s_and_b32 s60, s60, 3
    s_cmp_lt_u32 s60, 2
    s_cbranch_scc1 k2_pr01_5
    s_cmp_eq_u32 s60, 2
    s_cbranch_scc1 k2_pr2_5
    s_setprio 3
    s_branch k2_prd_5
k2_pr2_5:
    s_setprio 2
    s_branch k2_prd_5
k2_pr01_5:
    s_cmp_eq_u32 s60, 0
    s_cbranch_scc1 k2_pr0_5
    s_setprio 1
    s_branch k2_prd_5
k2_pr0_5:
    s_setprio 0
k2_prd_5:
    s_mov_b64 exec, s[70:71]
    v_bfe_u32 v17, v14, 4, 12
    ds_inc_rtn_u32 v18, v17, v1 offset:0
    s_mov_b64 exec, -1
    s_cmp_le_u32 s16, 64
    s_cbranch_scc1 k2_skip6
    v_mfma_f32_16x16x32_bf16 v[60:63], v[36:39], v[20:23], 0
    v_mfma_f32_16x16x32_bf16 v[64:67], v[36:39], v[24:27], 0
    ds_read_b128 v[36:39], v2 offset:768
    s_waitcnt lgkmcnt(4)
    v_pk_lshlrev_b16 v48, v0, v48 op_sel_hi:[0,1]
    v_pk_lshlrev_b16 v49, v0, v49 op_sel_hi:[0,1]
    v_pk_lshlrev_b16 v50, v0, v50 op_sel_hi:[0,1]
    v_pk_lshlrev_b16 v51, v0, v51 op_sel_hi:[0,1]
    v_pk_ashrrev_i16 v48, 15, v48 op_sel_hi:[0,1]
    v_pk_ashrrev_i16 v49, 15, v49 op_sel_hi:[0,1]
    v_pk_ashrrev_i16 v50, 15, v50 op_sel_hi:[0,1]
    v_pk_ashrrev_i16 v51, 15, v51 op_sel_hi:[0,1]
    s_nop 1
    v_cvt_pk_bf16_f32 v60, v60, v61
    v_cvt_pk_bf16_f32 v61, v62, v63
    v_cvt_pk_bf16_f32 v62, v64, v65
    v_cvt_pk_bf16_f32 v63, v66, v67
    s_waitcnt lgkmcnt(2)
    v_and_b32 v52, v48, v52
    v_and_b32 v53, v49, v53
    v_and_b32 v54, v50, v54
    v_and_b32 v55, v51, v55
    v_and_b32 v56, v48, v56
    v_and_b32 v57, v49, v57
    v_and_b32 v58, v50, v58
    v_and_b32 v59, v51, v59
    v_mfma_f32_16x16x32_bf16 v[68:71], v[60:63], v[52:55], v[68:71]
    s_waitcnt lgkmcnt(0)
    v_and_b32 v36, v48, v36
    v_mfma_f32_16x16x32_bf16 v[72:75], v[60:63], v[56:59], v[72:75]
    v_and_b32 v37, v49, v37
    v_and_b32 v38, v50, v38
    v_and_b32 v39, v51, v39
    s_nop 1
    v_mfma_f32_16x16x32_bf16 v[76:79], v[60:63], v[36:39], v[76:79]
k2_skip6:
    s_waitcnt lgkmcnt(0)
    s_mov_b64 exec, s[70:71]
    v_min_u32 v18, 159, v18
    v_mad_u32_u24 v18, v17, 40, v18
    ds_write_b8 v18, v14 offset:1024
    v_lshlrev_b32 v18, 2, v18
    ds_write_b32 v18, v9 offset:26624
    s_mov_b64 exec, -1
    s_sub_u32 s42, s42, 128
    v_cmp_gt_i32 vcc, s42, v4
    v_lshl_add_u32 v19, v19, 5, v5
    s_mov_b64 exec, vcc
    buffer_load_dwordx4 v[36:39], v19, s[4:7], 0 offen
    s_mov_b64 exec, -1
    ds_read_u16 v19, v4 offset:27648
    ds_read_b128 v[48:51], v2 offset:1152
    ds_read_b128 v[52:55], v2 offset:192
    ds_read_b128 v[56:59], v2 offset:512
    v_readlane_b32 s39, v6, 7
    s_bfm_b64 s[70:71], s39, 0
    s_lshr_b32 s40, s39, 6
    s_mov_b64 exec, s[70:71]
    s_lshl_b32 s41, s40, 1
    buffer_load_ushort v14, v3, s[12:15], s40 offen
    buffer_load_dword v9, v1, s[8:11], s41 offen
    s_mov_b64 exec, -1
    s_waitcnt vmcnt(12)
    s_mov_b64 exec, s[72:73]
    v_bfe_u32 v17, v15, 4, 12
    ds_inc_rtn_u32 v18, v17, v1 offset:0
    s_mov_b64 exec, -1
    s_cmp_le_u32 s16, 96
    s_cbranch_scc1 k2_skip7
    v_mfma_f32_16x16x32_bf16 v[60:63], v[40:43], v[20:23], 0
    v_mfma_f32_16x16x32_bf16 v[64:67], v[40:43], v[24:27], 0
    ds_read_b128 v[40:43], v2 offset:832
    s_waitcnt lgkmcnt(4)
    v_pk_lshlrev_b16 v48, v0, v48 op_sel_hi:[0,1]
    v_pk_lshlrev_b16 v49, v0, v49 op_sel_hi:[0,1]
    v_pk_lshlrev_b16 v50, v0, v50 op_sel_hi:[0,1]
    v_pk_lshlrev_b16 v51, v0, v51 op_sel_hi:[0,1]
    v_pk_ashrrev_i16 v48, 15, v48 op_sel_hi:[0,1]
    v_pk_ashrrev_i16 v49, 15, v49 op_sel_hi:[0,1]
    v_pk_ashrrev_i16 v50, 15, v50 op_sel_hi:[0,1]
    v_pk_ashrrev_i16 v51, 15, v51 op_sel_hi:[0,1]
    s_nop 1
    v_cvt_pk_bf16_f32 v60, v60, v61
    v_cvt_pk_bf16_f32 v61, v62, v63
    v_cvt_pk_bf16_f32 v62, v64, v65
    v_cvt_pk_bf16_f32 v63, v66, v67
    s_waitcnt lgkmcnt(2)
    v_and_b32 v52, v48, v52
    v_and_b32 v53, v49, v53
    v_and_b32 v54, v50, v54
    v_and_b32 v55, v51, v55
    v_and_b32 v56, v48, v56
    v_and_b32 v57, v49, v57
    v_and_b32 v58, v50, v58
    v_and_b32 v59, v51, v59
    v_mfma_f32_16x16x32_bf16 v[68:71], v[60:63], v[52:55], v[68:71]
    s_waitcnt lgkmcnt(0)
    v_and_b32 v40, v48, v40
    v_mfma_f32_16x16x32_bf16 v[72:75], v[60:63], v[56:59], v[72:75]
    v_and_b32 v41, v49, v41
    v_and_b32 v42, v50, v42
    v_and_b32 v43, v51, v43
    s_nop 1
    v_mfma_f32_16x16x32_bf16 v[76:79], v[60:63], v[40:43], v[76:79]
k2_skip7:
    s_waitcnt lgkmcnt(0)
    s_mov_b64 exec, s[72:73]
    v_min_u32 v18, 159, v18
    v_mad_u32_u24 v18, v17, 40, v18
    ds_write_b8 v18, v15 offset:1024
    v_lshlrev_b32 v18, 2, v18
    ds_write_b32 v18, v10 offset:26624
    s_mov_b64 exec, -1
    s_sub_u32 s42, s42, 128
    v_cmp_gt_i32 vcc, s42, v4
    v_lshl_add_u32 v19, v19, 5, v5
    s_mov_b64 exec, vcc
    buffer_load_dwordx4 v[40:43], v19, s[4:7], 0 offen
    s_mov_b64 exec, -1
    ds_read_u16 v19, v4 offset:27776
    v_lshlrev_b32 v51, 2, v3
    ds_read_b64 v[48:49], v51 offset:27264
    ds_read_u16 v50, v3 offset:1184
    v_readlane_b32 s39, v6, 8
    s_bfm_b64 s[72:73], s39, 0
    s_lshr_b32 s40, s39, 6
    s_mov_b64 exec, s[72:73]
    s_lshl_b32 s41, s40, 1
    buffer_load_ushort v15, v3, s[12:15], s40 offen
    buffer_load_dword v10, v1, s[8:11], s41 offen
    s_mov_b64 exec, -1
    s_waitcnt vmcnt(12)
    s_mov_b64 exec, s[74:75]
    v_bfe_u32 v17, v16, 4, 12
    ds_inc_rtn_u32 v18, v17, v1 offset:0
    s_mov_b64 exec, -1
    s_cmp_gt_u32 s16, 128
    s_cbranch_scc1 k2_rare8
k2_rareb8:
    s_waitcnt lgkmcnt(1)
    s_cmp_eq_u32 s17, 0
    s_cbranch_scc1 k2_pre_skip9
    v_mov_b32 v51, 0x1010
    v_lshrrev_b32 v52, 8, v50
    v_and_b32 v48, 0xffff0000, v48
    v_and_b32 v49, 0xffff0000, v49
    ds_write_b16 v3, v51 offset:1184
    v_lshrrev_b32 v50, v50, s43
    v_lshrrev_b32 v52, v52, s43
    v_mul_f32 v53, 0.15915494, v48
    v_mul_f32 v55, 0x40400000, v48
    v_mul_f32 v56, 0.15915494, v49
    v_mul_f32 v58, 0x40400000, v49
    v_fract_f32 v53, v53
    v_cvt_pk_bf16_f32 v55, 0, v55
    v_fract_f32 v56, v56
    v_cvt_pk_bf16_f32 v58, 0, v58
    v_cos_f32 v53, v53
    v_mul_f32 v55, 0.15915494, v55
    v_cos_f32 v56, v56
    v_mul_f32 v58, 0.15915494, v58
    v_fract_f32 v55, v55
    v_fract_f32 v58, v58
    v_mul_f32 v54, v53, v53
    v_mul_f32 v57, v56, v56
    v_cos_f32 v55, v55
    v_cos_f32 v58, v58
    v_fma_f32 v54, 2.0, v54, -1.0
    v_fma_f32 v57, 2.0, v57, -1.0
    v_lshl_or_b32 v50, v52, 16, v50
    v_cvt_pk_bf16_f32 v53, v53, v56
    v_cvt_pk_bf16_f32 v55, v55, v58
    ds_write_b32 v1, v50 offset:960
    v_cvt_pk_bf16_f32 v54, v54, v57
    ds_write_b32 v1, v53 offset:0
    ds_write_b32 v1, v55 offset:640
    ds_write_b32 v1, v54 offset:320
    s_waitcnt lgkmcnt(5)
    s_cmp_gt_u32 s17, 128
    s_cbranch_scc1 k2_pre2_9
k2_pre_end9:
    s_mov_b64 exec, s[74:75]
    v_min_u32 v18, 159, v18
    v_mad_u32_u24 v18, v17, 40, v18
    ds_write_b8 v18, v16 offset:1024
    v_lshlrev_b32 v18, 2, v18
    ds_write_b32 v18, v11 offset:26624
    s_mov_b64 exec, -1
    s_sub_u32 s42, s42, 128
    v_cmp_gt_i32 vcc, s42, v4
    v_lshl_add_u32 v19, v19, 5, v5
    s_mov_b64 exec, vcc
    buffer_load_dwordx4 v[44:47], v19, s[4:7], 0 offen
    s_mov_b64 exec, -1
    ds_read_u16 v19, v4 offset:27904
    ds_read_b128 v[48:51], v2 offset:960
    ds_read_b128 v[52:55], v2 offset:0
    ds_read_b128 v[56:59], v2 offset:320
    v_readlane_b32 s39, v6, 9
    s_bfm_b64 s[74:75], s39, 0
    s_lshr_b32 s40, s39, 6
    s_mov_b64 exec, s[74:75]
    s_lshl_b32 s41, s40, 1
    buffer_load_ushort v16, v3, s[12:15], s40 offen
    buffer_load_dword v11, v1, s[8:11], s41 offen
    s_mov_b64 exec, -1
    s_waitcnt vmcnt(12)
    s_add_u32 s60, s60, 1
    s_and_b32 s60, s60, 3
    s_cmp_lt_u32 s60, 2
    s_cbranch_scc1 k2_pr01_10
    s_cmp_eq_u32 s60, 2
    s_cbranch_scc1 k2_pr2_10
    s_setprio 3
    s_branch k2_prd_10
k2_pr2_10:
    s_setprio 2
    s_branch k2_prd_10
k2_pr01_10:
    s_cmp_eq_u32 s60, 0
    s_cbranch_scc1 k2_pr0_10
    s_setprio 1
    s_branch k2_prd_10
k2_pr0_10:
    s_setprio 0
k2_prd_10:
    s_mov_b64 exec, s[66:67]
    v_bfe_u32 v17, v12, 4, 12
    ds_inc_rtn_u32 v18, v17, v1 offset:0
    s_mov_b64 exec, -1
    s_cmp_le_u32 s17, 0
    s_cbranch_scc1 k2_skip11
    v_mfma_f32_16x16x32_bf16 v[60:63], v[28:31], v[20:23], 0
    v_mfma_f32_16x16x32_bf16 v[64:67], v[28:31], v[24:27], 0
    ds_read_b128 v[28:31], v2 offset:640
    s_waitcnt lgkmcnt(4)
    v_pk_lshlrev_b16 v48, v0, v48 op_sel_hi:[0,1]
    v_pk_lshlrev_b16 v49, v0, v49 op_sel_hi:[0,1]
    v_pk_lshlrev_b16 v50, v0, v50 op_sel_hi:[0,1]
    v_pk_lshlrev_b16 v51, v0, v51 op_sel_hi:[0,1]
    v_pk_ashrrev_i16 v48, 15, v48 op_sel_hi:[0,1]
    v_pk_ashrrev_i16 v49, 15, v49 op_sel_hi:[0,1]
    v_pk_ashrrev_i16 v50, 15, v50 op_sel_hi:[0,1]
    v_pk_ashrrev_i16 v51, 15, v51 op_sel_hi:[0,1]
    s_nop 1
    v_cvt_pk_bf16_f32 v60, v60, v61
    v_cvt_pk_bf16_f32 v61, v62, v63
    v_cvt_pk_bf16_f32 v62, v64, v65
    v_cvt_pk_bf16_f32 v63, v66, v67
    s_waitcnt lgkmcnt(2)
    v_and_b32 v52, v48, v52
    v_and_b32 v53, v49, v53
    v_and_b32 v54, v50, v54
    v_and_b32 v55, v51, v55
    v_and_b32 v56, v48, v56
    v_and_b32 v57, v49, v57
    v_and_b32 v58, v50, v58
    v_and_b32 v59, v51, v59
    v_mfma_f32_16x16x32_bf16 v[80:83], v[60:63], v[52:55], v[80:83]
    s_waitcnt lgkmcnt(0)
    v_and_b32 v28, v48, v28
    v_mfma_f32_16x16x32_bf16 v[84:87], v[60:63], v[56:59], v[84:87]
    v_and_b32 v29, v49, v29
    v_and_b32 v30, v50, v30
    v_and_b32 v31, v51, v31
    s_nop 1
    v_mfma_f32_16x16x32_bf16 v[88:91], v[60:63], v[28:31], v[88:91]
k2_skip11:
    s_waitcnt lgkmcnt(0)
    s_mov_b64 exec, s[66:67]
    v_min_u32 v18, 159, v18
    v_mad_u32_u24 v18, v17, 40, v18
    ds_write_b8 v18, v12 offset:1024
    v_lshlrev_b32 v18, 2, v18
    ds_write_b32 v18, v7 offset:26624
    s_mov_b64 exec, -1
    s_lshl2_add_u32 s42, s18, s31
    v_cmp_gt_i32 vcc, s42, v4
    v_lshl_add_u32 v19, v19, 5, v5
    s_mov_b64 exec, vcc
    buffer_load_dwordx4 v[28:31], v19, s[4:7], 0 offen
    s_mov_b64 exec, -1
    ds_read_u16 v19, v4 offset:28032
    ds_read_b128 v[48:51], v2 offset:1024
    ds_read_b128 v[52:55], v2 offset:64
    ds_read_b128 v[56:59], v2 offset:384
    v_readlane_b32 s39, v6, 10
    s_bfm_b64 s[66:67], s39, 0
    s_lshr_b32 s40, s39, 6
    s_mov_b64 exec, s[66:67]
    s_lshl_b32 s41, s40, 1
    buffer_load_ushort v12, v3, s[12:15], s40 offen
    buffer_load_dword v7, v1, s[8:11], s41 offen
    s_mov_b64 exec, -1
    s_waitcnt vmcnt(12)
    s_mov_b64 exec, s[68:69]
    v_bfe_u32 v17, v13, 4, 12
    ds_inc_rtn_u32 v18, v17, v1 offset:0
    s_mov_b64 exec, -1
    s_cmp_le_u32 s17, 32
    s_cbranch_scc1 k2_skip12
    v_mfma_f32_16x16x32_bf16 v[60:63], v[32:35], v[20:23], 0
    v_mfma_f32_16x16x32_bf16 v[64:67], v[32:35], v[24:27], 0
    ds_read_b128 v[32:35], v2 offset:704
    s_waitcnt lgkmcnt(4)
    v_pk_lshlrev_b16 v48, v0, v48 op_sel_hi:[0,1]
    v_pk_lshlrev_b16 v49, v0, v49 op_sel_hi:[0,1]
    v_pk_lshlrev_b16 v50, v0, v50 op_sel_hi:[0,1]
    v_pk_lshlrev_b16 v51, v0, v51 op_sel_hi:[0,1]
    v_pk_ashrrev_i16 v48, 15, v48 op_sel_hi:[0,1]
    v_pk_ashrrev_i16 v49, 15, v49 op_sel_hi:[0,1]
    v_pk_ashrrev_i16 v50, 15, v50 op_sel_hi:[0,1]
    v_pk_ashrrev_i16 v51, 15, v51 op_sel_hi:[0,1]
    s_nop 1
    v_cvt_pk_bf16_f32 v60, v60, v61
    v_cvt_pk_bf16_f32 v61, v62, v63
    v_cvt_pk_bf16_f32 v62, v64, v65
    v_cvt_pk_bf16_f32 v63, v66, v67
    s_waitcnt lgkmcnt(2)
    v_and_b32 v52, v48, v52
    v_and_b32 v53, v49, v53
    v_and_b32 v54, v50, v54
    v_and_b32 v55, v51, v55
    v_and_b32 v56, v48, v56
    v_and_b32 v57, v49, v57
    v_and_b32 v58, v50, v58
    v_and_b32 v59, v51, v59
    v_mfma_f32_16x16x32_bf16 v[80:83], v[60:63], v[52:55], v[80:83]
    s_waitcnt lgkmcnt(0)
    v_and_b32 v32, v48, v32
    v_mfma_f32_16x16x32_bf16 v[84:87], v[60:63], v[56:59], v[84:87]
    v_and_b32 v33, v49, v33
    v_and_b32 v34, v50, v34
    v_and_b32 v35, v51, v35
    s_nop 1
    v_mfma_f32_16x16x32_bf16 v[88:91], v[60:63], v[32:35], v[88:91]
k2_skip12:
    s_waitcnt lgkmcnt(0)
    s_mov_b64 exec, s[68:69]
    v_min_u32 v18, 159, v18
    v_mad_u32_u24 v18, v17, 40, v18
    ds_write_b8 v18, v13 offset:1024
    v_lshlrev_b32 v18, 2, v18
    ds_write_b32 v18, v8 offset:26624
    s_mov_b64 exec, -1
    s_sub_u32 s42, s42, 128
    v_cmp_gt_i32 vcc, s42, v4
    v_lshl_add_u32 v19, v19, 5, v5
    s_mov_b64 exec, vcc
    buffer_load_dwordx4 v[32:35], v19, s[4:7], 0 offen
    s_mov_b64 exec, -1
    ds_read_u16 v19, v4 offset:28160
    ds_read_b128 v[48:51], v2 offset:1088
    ds_read_b128 v[52:55], v2 offset:128
    ds_read_b128 v[56:59], v2 offset:448
    v_readlane_b32 s39, v6, 11
    s_bfm_b64 s[68:69], s39, 0
    s_lshr_b32 s40, s39, 6
    s_mov_b64 exec, s[68:69]
    s_lshl_b32 s41, s40, 1
    buffer_load_ushort v13, v3, s[12:15], s40 offen
    buffer_load_dword v8, v1, s[8:11], s41 offen
    s_mov_b64 exec, -1
    s_waitcnt vmcnt(12)
    s_add_u32 s60, s60, 1
    s_and_b32 s60, s60, 3
    s_cmp_lt_u32 s60, 2
    s_cbranch_scc1 k2_pr01_13
    s_cmp_eq_u32 s60, 2
    s_cbranch_scc1 k2_pr2_13
    s_setprio 3
    s_branch k2_prd_13
k2_pr2_13:
    s_setprio 2
    s_branch k2_prd_13
k2_pr01_13:
    s_cmp_eq_u32 s60, 0
    s_cbranch_scc1 k2_pr0_13
    s_setprio 1
    s_branch k2_prd_13
k2_pr0_13:
    s_setprio 0
k2_prd_13:
    s_mov_b64 exec, s[70:71]
    v_bfe_u32 v17, v14, 4, 12
    ds_inc_rtn_u32 v18, v17, v1 offset:0
    s_mov_b64 exec, -1
    s_cmp_le_u32 s17, 64
    s_cbranch_scc1 k2_skip14
    v_mfma_f32_16x16x32_bf16 v[60:63], v[36:39], v[20:23], 0
    v_mfma_f32_16x16x32_bf16 v[64:67], v[36:39], v[24:27], 0
    ds_read_b128 v[36:39], v2 offset:768
    s_waitcnt lgkmcnt(4)
    v_pk_lshlrev_b16 v48, v0, v48 op_sel_hi:[0,1]
    v_pk_lshlrev_b16 v49, v0, v49 op_sel_hi:[0,1]
    v_pk_lshlrev_b16 v50, v0, v50 op_sel_hi:[0,1]
    v_pk_lshlrev_b16 v51, v0, v51 op_sel_hi:[0,1]
    v_pk_ashrrev_i16 v48, 15, v48 op_sel_hi:[0,1]
    v_pk_ashrrev_i16 v49, 15, v49 op_sel_hi:[0,1]
    v_pk_ashrrev_i16 v50, 15, v50 op_sel_hi:[0,1]
    v_pk_ashrrev_i16 v51, 15, v51 op_sel_hi:[0,1]
    s_nop 1
    v_cvt_pk_bf16_f32 v60, v60, v61
    v_cvt_pk_bf16_f32 v61, v62, v63
    v_cvt_pk_bf16_f32 v62, v64, v65
    v_cvt_pk_bf16_f32 v63, v66, v67
    s_waitcnt lgkmcnt(2)
    v_and_b32 v52, v48, v52
    v_and_b32 v53, v49, v53
    v_and_b32 v54, v50, v54
    v_and_b32 v55, v51, v55
    v_and_b32 v56, v48, v56
    v_and_b32 v57, v49, v57
    v_and_b32 v58, v50, v58
    v_and_b32 v59, v51, v59
    v_mfma_f32_16x16x32_bf16 v[80:83], v[60:63], v[52:55], v[80:83]
    s_waitcnt lgkmcnt(0)
    v_and_b32 v36, v48, v36
    v_mfma_f32_16x16x32_bf16 v[84:87], v[60:63], v[56:59], v[84:87]
    v_and_b32 v37, v49, v37
    v_and_b32 v38, v50, v38
    v_and_b32 v39, v51, v39
    s_nop 1
    v_mfma_f32_16x16x32_bf16 v[88:91], v[60:63], v[36:39], v[88:91]
k2_skip14:
    s_waitcnt lgkmcnt(0)
    s_mov_b64 exec, s[70:71]
    v_min_u32 v18, 159, v18
    v_mad_u32_u24 v18, v17, 40, v18
    ds_write_b8 v18, v14 offset:1024
    v_lshlrev_b32 v18, 2, v18
    ds_write_b32 v18, v9 offset:26624
    s_mov_b64 exec, -1
    s_sub_u32 s42, s42, 128
    v_cmp_gt_i32 vcc, s42, v4
    v_lshl_add_u32 v19, v19, 5, v5
    s_mov_b64 exec, vcc
    buffer_load_dwordx4 v[36:39], v19, s[4:7], 0 offen
    s_mov_b64 exec, -1
    ds_read_u16 v19, v4 offset:28288
    ds_read_b128 v[48:51], v2 offset:1152
    ds_read_b128 v[52:55], v2 offset:192
    ds_read_b128 v[56:59], v2 offset:512
    v_readlane_b32 s39, v6, 12
    s_bfm_b64 s[70:71], s39, 0
    s_lshr_b32 s40, s39, 6
    s_mov_b64 exec, s[70:71]
    s_lshl_b32 s41, s40, 1
    buffer_load_ushort v14, v3, s[12:15], s40 offen
    buffer_load_dword v9, v1, s[8:11], s41 offen
    s_mov_b64 exec, -1
    s_waitcnt vmcnt(12)
    s_mov_b64 exec, s[72:73]
    v_bfe_u32 v17, v15, 4, 12
    ds_inc_rtn_u32 v18, v17, v1 offset:0
    s_mov_b64 exec, -1
    s_cmp_le_u32 s17, 96
    s_cbranch_scc1 k2_skip15
    v_mfma_f32_16x16x32_bf16 v[60:63], v[40:43], v[20:23], 0
    v_mfma_f32_16x16x32_bf16 v[64:67], v[40:43], v[24:27], 0
    ds_read_b128 v[40:43], v2 offset:832
    s_waitcnt lgkmcnt(4)
    v_pk_lshlrev_b16 v48, v0, v48 op_sel_hi:[0,1]
    v_pk_lshlrev_b16 v49, v0, v49 op_sel_hi:[0,1]
    v_pk_lshlrev_b16 v50, v0, v50 op_sel_hi:[0,1]
    v_pk_lshlrev_b16 v51, v0, v51 op_sel_hi:[0,1]
    v_pk_ashrrev_i16 v48, 15, v48 op_sel_hi:[0,1]
    v_pk_ashrrev_i16 v49, 15, v49 op_sel_hi:[0,1]
    v_pk_ashrrev_i16 v50, 15, v50 op_sel_hi:[0,1]
    v_pk_ashrrev_i16 v51, 15, v51 op_sel_hi:[0,1]
    s_nop 1
    v_cvt_pk_bf16_f32 v60, v60, v61
    v_cvt_pk_bf16_f32 v61, v62, v63
    v_cvt_pk_bf16_f32 v62, v64, v65
    v_cvt_pk_bf16_f32 v63, v66, v67
    s_waitcnt lgkmcnt(2)
    v_and_b32 v52, v48, v52
    v_and_b32 v53, v49, v53
    v_and_b32 v54, v50, v54
    v_and_b32 v55, v51, v55
    v_and_b32 v56, v48, v56
    v_and_b32 v57, v49, v57
    v_and_b32 v58, v50, v58
    v_and_b32 v59, v51, v59
    v_mfma_f32_16x16x32_bf16 v[80:83], v[60:63], v[52:55], v[80:83]
    s_waitcnt lgkmcnt(0)
    v_and_b32 v40, v48, v40
    v_mfma_f32_16x16x32_bf16 v[84:87], v[60:63], v[56:59], v[84:87]
    v_and_b32 v41, v49, v41
    v_and_b32 v42, v50, v42
    v_and_b32 v43, v51, v43
    s_nop 1
    v_mfma_f32_16x16x32_bf16 v[88:91], v[60:63], v[40:43], v[88:91]
k2_skip15:
    s_waitcnt lgkmcnt(0)
    s_mov_b64 exec, s[72:73]
    v_min_u32 v18, 159, v18
    v_mad_u32_u24 v18, v17, 40, v18
    ds_write_b8 v18, v15 offset:1024
    v_lshlrev_b32 v18, 2, v18
    ds_write_b32 v18, v10 offset:26624
    s_mov_b64 exec, -1
    s_sub_u32 s42, s42, 128
    v_cmp_gt_i32 vcc, s42, v4
    v_lshl_add_u32 v19, v19, 5, v5
    s_mov_b64 exec, vcc
    buffer_load_dwordx4 v[40:43], v19, s[4:7], 0 offen
    s_mov_b64 exec, -1
    ds_read_u16 v19, v4 offset:28416
    v_lshlrev_b32 v51, 2, v3
    ds_read_b64 v[48:49], v51 offset:27904
    ds_read_u16 v50, v3 offset:1344
    v_readlane_b32 s39, v6, 13
    s_bfm_b64 s[72:73], s39, 0
    s_lshr_b32 s40, s39, 6
    s_mov_b64 exec, s[72:73]
    s_lshl_b32 s41, s40, 1
    buffer_load_ushort v15, v3, s[12:15], s40 offen
    buffer_load_dword v10, v1, s[8:11], s41 offen
    s_mov_b64 exec, -1
    s_waitcnt vmcnt(12)
    s_mov_b64 exec, s[74:75]
    v_bfe_u32 v17, v16, 4, 12
    ds_inc_rtn_u32 v18, v17, v1 offset:0
    s_mov_b64 exec, -1
    s_cmp_gt_u32 s17, 128
    s_cbranch_scc1 k2_rare16
k2_rareb16:
    s_waitcnt lgkmcnt(1)
    s_cmp_eq_u32 s18, 0
    s_cbranch_scc1 k2_pre_skip17
    v_mov_b32 v51, 0x1010
    v_lshrrev_b32 v52, 8, v50
    v_and_b32 v48, 0xffff0000, v48
    v_and_b32 v49, 0xffff0000, v49
    ds_write_b16 v3, v51 offset:1344
    v_lshrrev_b32 v50, v50, s43
    v_lshrrev_b32 v52, v52, s43
    v_mul_f32 v53, 0.15915494, v48
    v_mul_f32 v55, 0x40400000, v48
    v_mul_f32 v56, 0.15915494, v49
    v_mul_f32 v58, 0x40400000, v49
    v_fract_f32 v53, v53
    v_cvt_pk_bf16_f32 v55, 0, v55
    v_fract_f32 v56, v56
    v_cvt_pk_bf16_f32 v58, 0, v58
    v_cos_f32 v53, v53
    v_mul_f32 v55, 0.15915494, v55
    v_cos_f32 v56, v56
    v_mul_f32 v58, 0.15915494, v58
    v_fract_f32 v55, v55
    v_fract_f32 v58, v58
    v_mul_f32 v54, v53, v53
    v_mul_f32 v57, v56, v56
    v_cos_f32 v55, v55
    v_cos_f32 v58, v58
    v_fma_f32 v54, 2.0, v54, -1.0
    v_fma_f32 v57, 2.0, v57, -1.0
    v_lshl_or_b32 v50, v52, 16, v50
    v_cvt_pk_bf16_f32 v53, v53, v56
    v_cvt_pk_bf16_f32 v55, v55, v58
    ds_write_b32 v1, v50 offset:960
    v_cvt_pk_bf16_f32 v54, v54, v57
    ds_write_b32 v1, v53 offset:0
    ds_write_b32 v1, v55 offset:640
    ds_write_b32 v1, v54 offset:320
    s_waitcnt lgkmcnt(5)
    s_cmp_gt_u32 s18, 128
    s_cbranch_scc1 k2_pre2_17
k2_pre_end17:
    s_mov_b64 exec, s[74:75]
    v_min_u32 v18, 159, v18
    v_mad_u32_u24 v18, v17, 40, v18
    ds_write_b8 v18, v16 offset:1024
    v_lshlrev_b32 v18, 2, v18
    ds_write_b32 v18, v11 offset:26624
    s_mov_b64 exec, -1
    s_sub_u32 s42, s42, 128
    v_cmp_gt_i32 vcc, s42, v4
    v_lshl_add_u32 v19, v19, 5, v5
    s_mov_b64 exec, vcc
    buffer_load_dwordx4 v[44:47], v19, s[4:7], 0 offen
    s_mov_b64 exec, -1
    ds_read_u16 v19, v4 offset:28544
    ds_read_b128 v[48:51], v2 offset:960
    ds_read_b128 v[52:55], v2 offset:0
    ds_read_b128 v[56:59], v2 offset:320
    v_readlane_b32 s39, v6, 14
    s_bfm_b64 s[74:75], s39, 0
    s_lshr_b32 s40, s39, 6
    s_mov_b64 exec, s[74:75]
    s_lshl_b32 s41, s40, 1
    buffer_load_ushort v16, v3, s[12:15], s40 offen
    buffer_load_dword v11, v1, s[8:11], s41 offen
    s_mov_b64 exec, -1
    s_waitcnt vmcnt(12)
    s_add_u32 s60, s60, 1
    s_and_b32 s60, s60, 3
    s_cmp_lt_u32 s60, 2
    s_cbranch_scc1 k2_pr01_18
    s_cmp_eq_u32 s60, 2
    s_cbranch_scc1 k2_pr2_18
    s_setprio 3
    s_branch k2_prd_18
k2_pr2_18:
    s_setprio 2
    s_branch k2_prd_18
k2_pr01_18:
    s_cmp_eq_u32 s60, 0
    s_cbranch_scc1 k2_pr0_18
    s_setprio 1
    s_branch k2_prd_18
k2_pr0_18:
    s_setprio 0
k2_prd_18:
    s_mov_b64 exec, s[66:67]
    v_bfe_u32 v17, v12, 4, 12
    ds_inc_rtn_u32 v18, v17, v1 offset:0
    s_mov_b64 exec, -1
    s_cmp_le_u32 s18, 0
    s_cbranch_scc1 k2_skip19
    v_mfma_f32_16x16x32_bf16 v[60:63], v[28:31], v[20:23], 0
    v_mfma_f32_16x16x32_bf16 v[64:67], v[28:31], v[24:27], 0
    ds_read_b128 v[28:31], v2 offset:640
    s_waitcnt lgkmcnt(4)
    v_pk_lshlrev_b16 v48, v0, v48 op_sel_hi:[0,1]
    v_pk_lshlrev_b16 v49, v0, v49 op_sel_hi:[0,1]
    v_pk_lshlrev_b16 v50, v0, v50 op_sel_hi:[0,1]
    v_pk_lshlrev_b16 v51, v0, v51 op_sel_hi:[0,1]
    v_pk_ashrrev_i16 v48, 15, v48 op_sel_hi:[0,1]
    v_pk_ashrrev_i16 v49, 15, v49 op_sel_hi:[0,1]
    v_pk_ashrrev_i16 v50, 15, v50 op_sel_hi:[0,1]
    v_pk_ashrrev_i16 v51, 15, v51 op_sel_hi:[0,1]
    s_nop 1
    v_cvt_pk_bf16_f32 v60, v60, v61
    v_cvt_pk_bf16_f32 v61, v62, v63
    v_cvt_pk_bf16_f32 v62, v64, v65
    v_cvt_pk_bf16_f32 v63, v66, v67
    s_waitcnt lgkmcnt(2)
    v_and_b32 v52, v48, v52
    v_and_b32 v53, v49, v53
    v_and_b32 v54, v50, v54
    v_and_b32 v55, v51, v55
    v_and_b32 v56, v48, v56
    v_and_b32 v57, v49, v57
    v_and_b32 v58, v50, v58
    v_and_b32 v59, v51, v59
    v_mfma_f32_16x16x32_bf16 v[92:95], v[60:63], v[52:55], v[92:95]
    s_waitcnt lgkmcnt(0)
    v_and_b32 v28, v48, v28
    v_mfma_f32_16x16x32_bf16 v[96:99], v[60:63], v[56:59], v[96:99]
    v_and_b32 v29, v49, v29
    v_and_b32 v30, v50, v30
    v_and_b32 v31, v51, v31
    s_nop 1
    v_mfma_f32_16x16x32_bf16 v[100:103], v[60:63], v[28:31], v[100:103]
k2_skip19:
    s_waitcnt lgkmcnt(0)
    s_mov_b64 exec, s[66:67]
    v_min_u32 v18, 159, v18
    v_mad_u32_u24 v18, v17, 40, v18
    ds_write_b8 v18, v12 offset:1024
    v_lshlrev_b32 v18, 2, v18
    ds_write_b32 v18, v7 offset:26624
    s_mov_b64 exec, -1
    s_lshl2_add_u32 s42, s19, s31
    v_cmp_gt_i32 vcc, s42, v4
    v_lshl_add_u32 v19, v19, 5, v5
    s_mov_b64 exec, vcc
    buffer_load_dwordx4 v[28:31], v19, s[4:7], 0 offen
    s_mov_b64 exec, -1
    ds_read_u16 v19, v4 offset:28672
    ds_read_b128 v[48:51], v2 offset:1024
    ds_read_b128 v[52:55], v2 offset:64
    ds_read_b128 v[56:59], v2 offset:384
    v_readlane_b32 s39, v6, 15
    s_bfm_b64 s[66:67], s39, 0
    s_lshr_b32 s40, s39, 6
    s_mov_b64 exec, s[66:67]
    s_lshl_b32 s41, s40, 1
    buffer_load_ushort v12, v3, s[12:15], s40 offen
    buffer_load_dword v7, v1, s[8:11], s41 offen
    s_mov_b64 exec, -1
    s_waitcnt vmcnt(12)
    s_mov_b64 exec, s[68:69]
    v_bfe_u32 v17, v13, 4, 12
    ds_inc_rtn_u32 v18, v17, v1 offset:0
    s_mov_b64 exec, -1
    s_cmp_le_u32 s18, 32
    s_cbranch_scc1 k2_skip20
    v_mfma_f32_16x16x32_bf16 v[60:63], v[32:35], v[20:23], 0
    v_mfma_f32_16x16x32_bf16 v[64:67], v[32:35], v[24:27], 0
    ds_read_b128 v[32:35], v2 offset:704
    s_waitcnt lgkmcnt(4)
    v_pk_lshlrev_b16 v48, v0, v48 op_sel_hi:[0,1]
    v_pk_lshlrev_b16 v49, v0, v49 op_sel_hi:[0,1]
    v_pk_lshlrev_b16 v50, v0, v50 op_sel_hi:[0,1]
    v_pk_lshlrev_b16 v51, v0, v51 op_sel_hi:[0,1]
    v_pk_ashrrev_i16 v48, 15, v48 op_sel_hi:[0,1]
    v_pk_ashrrev_i16 v49, 15, v49 op_sel_hi:[0,1]
    v_pk_ashrrev_i16 v50, 15, v50 op_sel_hi:[0,1]
    v_pk_ashrrev_i16 v51, 15, v51 op_sel_hi:[0,1]
    s_nop 1
    v_cvt_pk_bf16_f32 v60, v60, v61
    v_cvt_pk_bf16_f32 v61, v62, v63
    v_cvt_pk_bf16_f32 v62, v64, v65
    v_cvt_pk_bf16_f32 v63, v66, v67
    s_waitcnt lgkmcnt(2)
    v_and_b32 v52, v48, v52
    v_and_b32 v53, v49, v53
    v_and_b32 v54, v50, v54
    v_and_b32 v55, v51, v55
    v_and_b32 v56, v48, v56
    v_and_b32 v57, v49, v57
    v_and_b32 v58, v50, v58
    v_and_b32 v59, v51, v59
    v_mfma_f32_16x16x32_bf16 v[92:95], v[60:63], v[52:55], v[92:95]
    s_waitcnt lgkmcnt(0)
    v_and_b32 v32, v48, v32
    v_mfma_f32_16x16x32_bf16 v[96:99], v[60:63], v[56:59], v[96:99]
    v_and_b32 v33, v49, v33
    v_and_b32 v34, v50, v34
    v_and_b32 v35, v51, v35
    s_nop 1
    v_mfma_f32_16x16x32_bf16 v[100:103], v[60:63], v[32:35], v[100:103]
k2_skip20:
    s_waitcnt lgkmcnt(0)
    s_mov_b64 exec, s[68:69]
    v_min_u32 v18, 159, v18
    v_mad_u32_u24 v18, v17, 40, v18
    ds_write_b8 v18, v13 offset:1024
    v_lshlrev_b32 v18, 2, v18
    ds_write_b32 v18, v8 offset:26624
    s_mov_b64 exec, -1
    s_sub_u32 s42, s42, 128
    v_cmp_gt_i32 vcc, s42, v4
    v_lshl_add_u32 v19, v19, 5, v5
    s_mov_b64 exec, vcc
    buffer_load_dwordx4 v[32:35], v19, s[4:7], 0 offen
    s_mov_b64 exec, -1
    ds_read_u16 v19, v4 offset:28800
    ds_read_b128 v[48:51], v2 offset:1088
    ds_read_b128 v[52:55], v2 offset:128
    ds_read_b128 v[56:59], v2 offset:448
    s_add_u32 s39, s34, 2
    s_mul_i32 s41, s39, 1000
    s_add_u32 s41, s41, s48
    s_cmp_lt_u32 s39, 5
    s_cselect_b32 s40, 0, 0x40000000
    s_cselect_b32 s41, s41, 0
    v_mul_u32_u24 v6, 80000, v0
    v_add_u32 v67, s40, v6
    v_mov_b32 v6, 0
    s_mov_b64 exec, s[50:51]
    buffer_load_dword v6, v67, s[56:59], s41 offen
    s_mov_b64 exec, -1
    s_waitcnt vmcnt(11)
    s_add_u32 s60, s60, 1
    s_and_b32 s60, s60, 3
    s_cmp_lt_u32 s60, 2
    s_cbranch_scc1 k2_pr01_21
    s_cmp_eq_u32 s60, 2
    s_cbranch_scc1 k2_pr2_21
    s_setprio 3
    s_branch k2_prd_21
k2_pr2_21:
    s_setprio 2
    s_branch k2_prd_21
k2_pr01_21:
    s_cmp_eq_u32 s60, 0
    s_cbranch_scc1 k2_pr0_21
    s_setprio 1
    s_branch k2_prd_21
k2_pr0_21:
    s_setprio 0
k2_prd_21:
    s_mov_b64 exec, s[70:71]
    v_bfe_u32 v17, v14, 4, 12
    ds_inc_rtn_u32 v18, v17, v1 offset:0
    s_mov_b64 exec, -1
    s_cmp_le_u32 s18, 64
    s_cbranch_scc1 k2_skip22
    v_mfma_f32_16x16x32_bf16 v[60:63], v[36:39], v[20:23], 0
    v_mfma_f32_16x16x32_bf16 v[64:67], v[36:39], v[24:27], 0
    ds_read_b128 v[36:39], v2 offset:768
    s_waitcnt lgkmcnt(4)
    v_pk_lshlrev_b16 v48, v0, v48 op_sel_hi:[0,1]
    v_pk_lshlrev_b16 v49, v0, v49 op_sel_hi:[0,1]
    v_pk_lshlrev_b16 v50, v0, v50 op_sel_hi:[0,1]
    v_pk_lshlrev_b16 v51, v0, v51 op_sel_hi:[0,1]
    v_pk_ashrrev_i16 v48, 15, v48 op_sel_hi:[0,1]
    v_pk_ashrrev_i16 v49, 15, v49 op_sel_hi:[0,1]
    v_pk_ashrrev_i16 v50, 15, v50 op_sel_hi:[0,1]
    v_pk_ashrrev_i16 v51, 15, v51 op_sel_hi:[0,1]
    s_nop 1
    v_cvt_pk_bf16_f32 v60, v60, v61
    v_cvt_pk_bf16_f32 v61, v62, v63
    v_cvt_pk_bf16_f32 v62, v64, v65
    v_cvt_pk_bf16_f32 v63, v66, v67
    s_waitcnt lgkmcnt(2)
    v_and_b32 v52, v48, v52
    v_and_b32 v53, v49, v53
    v_and_b32 v54, v50, v54
    v_and_b32 v55, v51, v55
    v_and_b32 v56, v48, v56
    v_and_b32 v57, v49, v57
    v_and_b32 v58, v50, v58
    v_and_b32 v59, v51, v59
    v_mfma_f32_16x16x32_bf16 v[92:95], v[60:63], v[52:55], v[92:95]
    s_waitcnt lgkmcnt(0)
    v_and_b32 v36, v48, v36
    v_mfma_f32_16x16x32_bf16 v[96:99], v[60:63], v[56:59], v[96:99]
    v_and_b32 v37, v49, v37
    v_and_b32 v38, v50, v38
    v_and_b32 v39, v51, v39
    s_nop 1
    v_mfma_f32_16x16x32_bf16 v[100:103], v[60:63], v[36:39], v[100:103]
k2_skip22:
    s_waitcnt lgkmcnt(0)
    s_mov_b64 exec, s[70:71]
    v_min_u32 v18, 159, v18
    v_mad_u32_u24 v18, v17, 40, v18
    ds_write_b8 v18, v14 offset:1024
    v_lshlrev_b32 v18, 2, v18
    ds_write_b32 v18, v9 offset:26624
    s_mov_b64 exec, -1
    s_sub_u32 s42, s42, 128
    v_cmp_gt_i32 vcc, s42, v4
    v_lshl_add_u32 v19, v19, 5, v5
    s_mov_b64 exec, vcc
    buffer_load_dwordx4 v[36:39], v19, s[4:7], 0 offen
    s_mov_b64 exec, -1
    ds_read_u16 v19, v4 offset:28928
    ds_read_b128 v[48:51], v2 offset:1152
    ds_read_b128 v[52:55], v2 offset:192
    ds_read_b128 v[56:59], v2 offset:512
    s_waitcnt vmcnt(9)
    s_mov_b64 exec, s[72:73]
    v_bfe_u32 v17, v15, 4, 12
    ds_inc_rtn_u32 v18, v17, v1 offset:0
    s_mov_b64 exec, -1
    s_cmp_le_u32 s18, 96
    s_cbranch_scc1 k2_skip23
    v_mfma_f32_16x16x32_bf16 v[60:63], v[40:43], v[20:23], 0
    v_mfma_f32_16x16x32_bf16 v[64:67], v[40:43], v[24:27], 0
    ds_read_b128 v[40:43], v2 offset:832
    s_waitcnt lgkmcnt(4)
    v_pk_lshlrev_b16 v48, v0, v48 op_sel_hi:[0,1]
    v_pk_lshlrev_b16 v49, v0, v49 op_sel_hi:[0,1]
    v_pk_lshlrev_b16 v50, v0, v50 op_sel_hi:[0,1]
    v_pk_lshlrev_b16 v51, v0, v51 op_sel_hi:[0,1]
    v_pk_ashrrev_i16 v48, 15, v48 op_sel_hi:[0,1]
    v_pk_ashrrev_i16 v49, 15, v49 op_sel_hi:[0,1]
    v_pk_ashrrev_i16 v50, 15, v50 op_sel_hi:[0,1]
    v_pk_ashrrev_i16 v51, 15, v51 op_sel_hi:[0,1]
    s_nop 1
    v_cvt_pk_bf16_f32 v60, v60, v61
    v_cvt_pk_bf16_f32 v61, v62, v63
    v_cvt_pk_bf16_f32 v62, v64, v65
    v_cvt_pk_bf16_f32 v63, v66, v67
    s_waitcnt lgkmcnt(2)
    v_and_b32 v52, v48, v52
    v_and_b32 v53, v49, v53
    v_and_b32 v54, v50, v54
    v_and_b32 v55, v51, v55
    v_and_b32 v56, v48, v56
    v_and_b32 v57, v49, v57
    v_and_b32 v58, v50, v58
    v_and_b32 v59, v51, v59
    v_mfma_f32_16x16x32_bf16 v[92:95], v[60:63], v[52:55], v[92:95]
    s_waitcnt lgkmcnt(0)
    v_and_b32 v40, v48, v40
    v_mfma_f32_16x16x32_bf16 v[96:99], v[60:63], v[56:59], v[96:99]
    v_and_b32 v41, v49, v41
    v_and_b32 v42, v50, v42
    v_and_b32 v43, v51, v43
    s_nop 1
    v_mfma_f32_16x16x32_bf16 v[100:103], v[60:63], v[40:43], v[100:103]
k2_skip23:
    s_waitcnt lgkmcnt(0)
    s_mov_b64 exec, s[72:73]
    v_min_u32 v18, 159, v18
    v_mad_u32_u24 v18, v17, 40, v18
    ds_write_b8 v18, v15 offset:1024
    v_lshlrev_b32 v18, 2, v18
    ds_write_b32 v18, v10 offset:26624
    s_mov_b64 exec, -1
    s_sub_u32 s42, s42, 128
    v_cmp_gt_i32 vcc, s42, v4
    v_lshl_add_u32 v19, v19, 5, v5
    s_mov_b64 exec, vcc
    buffer_load_dwordx4 v[40:43], v19, s[4:7], 0 offen
    s_mov_b64 exec, -1
    ds_read_u16 v19, v4 offset:29056
    v_lshlrev_b32 v51, 2, v3
    ds_read_b64 v[48:49], v51 offset:28544
    ds_read_u16 v50, v3 offset:1504
    s_waitcnt vmcnt(7)
    s_mov_b64 exec, s[74:75]
    v_bfe_u32 v17, v16, 4, 12
    ds_inc_rtn_u32 v18, v17, v1 offset:0
    s_mov_b64 exec, -1
    s_cmp_gt_u32 s18, 128
    s_cbranch_scc1 k2_rare24
k2_rareb24:
    s_waitcnt lgkmcnt(1)
    s_cmp_eq_u32 s19, 0
    s_cbranch_scc1 k2_pre_skip25
    v_mov_b32 v51, 0x1010
    v_lshrrev_b32 v52, 8, v50
    v_and_b32 v48, 0xffff0000, v48
    v_and_b32 v49, 0xffff0000, v49
    ds_write_b16 v3, v51 offset:1504
    v_lshrrev_b32 v50, v50, s43
    v_lshrrev_b32 v52, v52, s43
    v_mul_f32 v53, 0.15915494, v48
    v_mul_f32 v55, 0x40400000, v48
    v_mul_f32 v56, 0.15915494, v49
    v_mul_f32 v58, 0x40400000, v49
    v_fract_f32 v53, v53
    v_cvt_pk_bf16_f32 v55, 0, v55
    v_fract_f32 v56, v56
    v_cvt_pk_bf16_f32 v58, 0, v58
    v_cos_f32 v53, v53
    v_mul_f32 v55, 0.15915494, v55
    v_cos_f32 v56, v56
    v_mul_f32 v58, 0.15915494, v58
    v_fract_f32 v55, v55
    v_fract_f32 v58, v58
    v_mul_f32 v54, v53, v53
    v_mul_f32 v57, v56, v56
    v_cos_f32 v55, v55
    v_cos_f32 v58, v58
    v_fma_f32 v54, 2.0, v54, -1.0
    v_fma_f32 v57, 2.0, v57, -1.0
    v_lshl_or_b32 v50, v52, 16, v50
    v_cvt_pk_bf16_f32 v53, v53, v56
    v_cvt_pk_bf16_f32 v55, v55, v58
    ds_write_b32 v1, v50 offset:960
    v_cvt_pk_bf16_f32 v54, v54, v57
    ds_write_b32 v1, v53 offset:0
    ds_write_b32 v1, v55 offset:640
    ds_write_b32 v1, v54 offset:320
    s_waitcnt lgkmcnt(5)
    s_cmp_gt_u32 s19, 128
    s_cbranch_scc1 k2_pre2_25
k2_pre_end25:
    s_mov_b64 exec, s[74:75]
    v_min_u32 v18, 159, v18
    v_mad_u32_u24 v18, v17, 40, v18
    ds_write_b8 v18, v16 offset:1024
    v_lshlrev_b32 v18, 2, v18
    ds_write_b32 v18, v11 offset:26624
    s_mov_b64 exec, -1
    s_sub_u32 s42, s42, 128
    v_cmp_gt_i32 vcc, s42, v4
    v_lshl_add_u32 v19, v19, 5, v5
    s_mov_b64 exec, vcc
    buffer_load_dwordx4 v[44:47], v19, s[4:7], 0 offen
    s_mov_b64 exec, -1
    ds_read_u16 v19, v4 offset:29184
    ds_read_b128 v[48:51], v2 offset:960
    ds_read_b128 v[52:55], v2 offset:0
    ds_read_b128 v[56:59], v2 offset:320
    s_waitcnt vmcnt(5)
    s_add_u32 s60, s60, 1
    s_and_b32 s60, s60, 3
    s_cmp_lt_u32 s60, 2
    s_cbranch_scc1 k2_pr01_26
    s_cmp_eq_u32 s60, 2
    s_cbranch_scc1 k2_pr2_26
    s_setprio 3
    s_branch k2_prd_26
k2_pr2_26:
    s_setprio 2
    s_branch k2_prd_26
k2_pr01_26:
    s_cmp_eq_u32 s60, 0
    s_cbranch_scc1 k2_pr0_26
    s_setprio 1
    s_branch k2_prd_26
k2_pr0_26:
    s_setprio 0
k2_prd_26:
    s_mov_b64 exec, s[66:67]
    v_bfe_u32 v17, v12, 4, 12
    ds_inc_rtn_u32 v18, v17, v1 offset:0
    s_mov_b64 exec, -1
    s_cmp_le_u32 s19, 0
    s_cbranch_scc1 k2_skip27
    v_mfma_f32_16x16x32_bf16 v[60:63], v[28:31], v[20:23], 0
    v_mfma_f32_16x16x32_bf16 v[64:67], v[28:31], v[24:27], 0
    ds_read_b128 v[28:31], v2 offset:640
    s_waitcnt lgkmcnt(4)
    v_pk_lshlrev_b16 v48, v0, v48 op_sel_hi:[0,1]
    v_pk_lshlrev_b16 v49, v0, v49 op_sel_hi:[0,1]
    v_pk_lshlrev_b16 v50, v0, v50 op_sel_hi:[0,1]
    v_pk_lshlrev_b16 v51, v0, v51 op_sel_hi:[0,1]
    v_pk_ashrrev_i16 v48, 15, v48 op_sel_hi:[0,1]
    v_pk_ashrrev_i16 v49, 15, v49 op_sel_hi:[0,1]
    v_pk_ashrrev_i16 v50, 15, v50 op_sel_hi:[0,1]
    v_pk_ashrrev_i16 v51, 15, v51 op_sel_hi:[0,1]
    s_nop 1
    v_cvt_pk_bf16_f32 v60, v60, v61
    v_cvt_pk_bf16_f32 v61, v62, v63
    v_cvt_pk_bf16_f32 v62, v64, v65
    v_cvt_pk_bf16_f32 v63, v66, v67
    s_waitcnt lgkmcnt(2)
    v_and_b32 v52, v48, v52
    v_and_b32 v53, v49, v53
    v_and_b32 v54, v50, v54
    v_and_b32 v55, v51, v55
    v_and_b32 v56, v48, v56
    v_and_b32 v57, v49, v57
    v_and_b32 v58, v50, v58
    v_and_b32 v59, v51, v59
    v_mfma_f32_16x16x32_bf16 v[104:107], v[60:63], v[52:55], v[104:107]
    s_waitcnt lgkmcnt(0)
    v_and_b32 v28, v48, v28
    v_mfma_f32_16x16x32_bf16 v[108:111], v[60:63], v[56:59], v[108:111]
    v_and_b32 v29, v49, v29
    v_and_b32 v30, v50, v30
    v_and_b32 v31, v51, v31
    s_nop 1
    v_mfma_f32_16x16x32_bf16 v[112:115], v[60:63], v[28:31], v[112:115]
k2_skip27:
    s_waitcnt lgkmcnt(0)
    s_mov_b64 exec, s[66:67]
    v_min_u32 v18, 159, v18
    v_mad_u32_u24 v18, v17, 40, v18
    ds_write_b8 v18, v12 offset:1024
    v_lshlrev_b32 v18, 2, v18
    ds_write_b32 v18, v7 offset:26624
    s_mov_b64 exec, -1
    s_lshl2_add_u32 s42, s20, s31
    v_cmp_gt_i32 vcc, s42, v4
    v_lshl_add_u32 v19, v19, 5, v5
    s_mov_b64 exec, vcc
    buffer_load_dwordx4 v[28:31], v19, s[4:7], 0 offen
    s_mov_b64 exec, -1
    ds_read_u16 v19, v4 offset:29312
    ds_read_b128 v[48:51], v2 offset:1024
    ds_read_b128 v[52:55], v2 offset:64
    ds_read_b128 v[56:59], v2 offset:384
    s_waitcnt vmcnt(4)
    s_cmp_le_u32 s19, 32
    s_cbranch_scc1 k2_skip28
    v_mfma_f32_16x16x32_bf16 v[60:63], v[32:35], v[20:23], 0
    v_mfma_f32_16x16x32_bf16 v[64:67], v[32:35], v[24:27], 0
    ds_read_b128 v[32:35], v2 offset:704
    s_waitcnt lgkmcnt(3)
    v_pk_lshlrev_b16 v48, v0, v48 op_sel_hi:[0,1]
    v_pk_lshlrev_b16 v49, v0, v49 op_sel_hi:[0,1]
    v_pk_lshlrev_b16 v50, v0, v50 op_sel_hi:[0,1]
    v_pk_lshlrev_b16 v51, v0, v51 op_sel_hi:[0,1]
    v_pk_ashrrev_i16 v48, 15, v48 op_sel_hi:[0,1]
    v_pk_ashrrev_i16 v49, 15, v49 op_sel_hi:[0,1]
    v_pk_ashrrev_i16 v50, 15, v50 op_sel_hi:[0,1]
    v_pk_ashrrev_i16 v51, 15, v51 op_sel_hi:[0,1]
    s_nop 1
    v_cvt_pk_bf16_f32 v60, v60, v61
    v_cvt_pk_bf16_f32 v61, v62, v63
    v_cvt_pk_bf16_f32 v62, v64, v65
    v_cvt_pk_bf16_f32 v63, v66, v67
    s_waitcnt lgkmcnt(1)
    v_and_b32 v52, v48, v52
    v_and_b32 v53, v49, v53
    v_and_b32 v54, v50, v54
    v_and_b32 v55, v51, v55
    v_and_b32 v56, v48, v56
    v_and_b32 v57, v49, v57
    v_and_b32 v58, v50, v58
    v_and_b32 v59, v51, v59
    v_mfma_f32_16x16x32_bf16 v[104:107], v[60:63], v[52:55], v[104:107]
    s_waitcnt lgkmcnt(0)
    v_and_b32 v32, v48, v32
    v_mfma_f32_16x16x32_bf16 v[108:111], v[60:63], v[56:59], v[108:111]
    v_and_b32 v33, v49, v33
    v_and_b32 v34, v50, v34
    v_and_b32 v35, v51, v35
    s_nop 1
    v_mfma_f32_16x16x32_bf16 v[112:115], v[60:63], v[32:35], v[112:115]
k2_skip28:
    s_waitcnt lgkmcnt(3)
    s_sub_u32 s42, s42, 128
    v_cmp_gt_i32 vcc, s42, v4
    v_lshl_add_u32 v19, v19, 5, v5
    s_mov_b64 exec, vcc
    buffer_load_dwordx4 v[32:35], v19, s[4:7], 0 offen
    s_mov_b64 exec, -1
    ds_read_u16 v19, v4 offset:29440
    ds_read_b128 v[48:51], v2 offset:1088
    ds_read_b128 v[52:55], v2 offset:128
    ds_read_b128 v[56:59], v2 offset:448
    s_waitcnt vmcnt(4)
    s_add_u32 s60, s60, 1
    s_and_b32 s60, s60, 3
    s_cmp_lt_u32 s60, 2
    s_cbranch_scc1 k2_pr01_29
    s_cmp_eq_u32 s60, 2
    s_cbranch_scc1 k2_pr2_29
    s_setprio 3
    s_branch k2_prd_29
k2_pr2_29:
    s_setprio 2
    s_branch k2_prd_29
k2_pr01_29:
    s_cmp_eq_u32 s60, 0
    s_cbranch_scc1 k2_pr0_29
    s_setprio 1
    s_branch k2_prd_29
k2_pr0_29:
    s_setprio 0
k2_prd_29:
    s_cmp_le_u32 s19, 64
    s_cbranch_scc1 k2_skip30
    v_mfma_f32_16x16x32_bf16 v[60:63], v[36:39], v[20:23], 0
    v_mfma_f32_16x16x32_bf16 v[64:67], v[36:39], v[24:27], 0
    ds_read_b128 v[36:39], v2 offset:768
    s_waitcnt lgkmcnt(3)
    v_pk_lshlrev_b16 v48, v0, v48 op_sel_hi:[0,1]
    v_pk_lshlrev_b16 v49, v0, v49 op_sel_hi:[0,1]
    v_pk_lshlrev_b16 v50, v0, v50 op_sel_hi:[0,1]
    v_pk_lshlrev_b16 v51, v0, v51 op_sel_hi:[0,1]
    v_pk_ashrrev_i16 v48, 15, v48 op_sel_hi:[0,1]
    v_pk_ashrrev_i16 v49, 15, v49 op_sel_hi:[0,1]
    v_pk_ashrrev_i16 v50, 15, v50 op_sel_hi:[0,1]
    v_pk_ashrrev_i16 v51, 15, v51 op_sel_hi:[0,1]
    s_nop 1
    v_cvt_pk_bf16_f32 v60, v60, v61
    v_cvt_pk_bf16_f32 v61, v62, v63
    v_cvt_pk_bf16_f32 v62, v64, v65
    v_cvt_pk_bf16_f32 v63, v66, v67
    s_waitcnt lgkmcnt(1)
    v_and_b32 v52, v48, v52
    v_and_b32 v53, v49, v53
    v_and_b32 v54, v50, v54
    v_and_b32 v55, v51, v55
    v_and_b32 v56, v48, v56
    v_and_b32 v57, v49, v57
    v_and_b32 v58, v50, v58
    v_and_b32 v59, v51, v59
    v_mfma_f32_16x16x32_bf16 v[104:107], v[60:63], v[52:55], v[104:107]
    s_waitcnt lgkmcnt(0)
    v_and_b32 v36, v48, v36
    v_mfma_f32_16x16x32_bf16 v[108:111], v[60:63], v[56:59], v[108:111]
    v_and_b32 v37, v49, v37
    v_and_b32 v38, v50, v38
    v_and_b32 v39, v51, v39
    s_nop 1
    v_mfma_f32_16x16x32_bf16 v[112:115], v[60:63], v[36:39], v[112:115]
k2_skip30:
    s_waitcnt lgkmcnt(3)
    s_sub_u32 s42, s42, 128
    v_cmp_gt_i32 vcc, s42, v4
    v_lshl_add_u32 v19, v19, 5, v5
    s_mov_b64 exec, vcc
    buffer_load_dwordx4 v[36:39], v19, s[4:7], 0 offen
    s_mov_b64 exec, -1
    ds_read_u16 v19, v4 offset:29568
    ds_read_b128 v[48:51], v2 offset:1152
    ds_read_b128 v[52:55], v2 offset:192
    ds_read_b128 v[56:59], v2 offset:512
    s_waitcnt vmcnt(4)
    s_cmp_le_u32 s19, 96
    s_cbranch_scc1 k2_skip31
    v_mfma_f32_16x16x32_bf16 v[60:63], v[40:43], v[20:23], 0
    v_mfma_f32_16x16x32_bf16 v[64:67], v[40:43], v[24:27], 0
    ds_read_b128 v[40:43], v2 offset:832
    s_waitcnt lgkmcnt(3)
    v_pk_lshlrev_b16 v48, v0, v48 op_sel_hi:[0,1]
    v_pk_lshlrev_b16 v49, v0, v49 op_sel_hi:[0,1]
    v_pk_lshlrev_b16 v50, v0, v50 op_sel_hi:[0,1]
    v_pk_lshlrev_b16 v51, v0, v51 op_sel_hi:[0,1]
    v_pk_ashrrev_i16 v48, 15, v48 op_sel_hi:[0,1]
    v_pk_ashrrev_i16 v49, 15, v49 op_sel_hi:[0,1]
    v_pk_ashrrev_i16 v50, 15, v50 op_sel_hi:[0,1]
    v_pk_ashrrev_i16 v51, 15, v51 op_sel_hi:[0,1]
    s_nop 1
    v_cvt_pk_bf16_f32 v60, v60, v61
    v_cvt_pk_bf16_f32 v61, v62, v63
    v_cvt_pk_bf16_f32 v62, v64, v65
    v_cvt_pk_bf16_f32 v63, v66, v67
    s_waitcnt lgkmcnt(1)
    v_and_b32 v52, v48, v52
    v_and_b32 v53, v49, v53
    v_and_b32 v54, v50, v54
    v_and_b32 v55, v51, v55
    v_and_b32 v56, v48, v56
    v_and_b32 v57, v49, v57
    v_and_b32 v58, v50, v58
    v_and_b32 v59, v51, v59
    v_mfma_f32_16x16x32_bf16 v[104:107], v[60:63], v[52:55], v[104:107]
    s_waitcnt lgkmcnt(0)
    v_and_b32 v40, v48, v40
    v_mfma_f32_16x16x32_bf16 v[108:111], v[60:63], v[56:59], v[108:111]
    v_and_b32 v41, v49, v41
    v_and_b32 v42, v50, v42
    v_and_b32 v43, v51, v43
    s_nop 1
    v_mfma_f32_16x16x32_bf16 v[112:115], v[60:63], v[40:43], v[112:115]
k2_skip31:
    s_waitcnt lgkmcnt(3)
    s_sub_u32 s42, s42, 128
    v_cmp_gt_i32 vcc, s42, v4
    v_lshl_add_u32 v19, v19, 5, v5
    s_mov_b64 exec, vcc
    buffer_load_dwordx4 v[40:43], v19, s[4:7], 0 offen
    s_mov_b64 exec, -1
    ds_read_u16 v19, v4 offset:29696
    v_lshlrev_b32 v51, 2, v3
    ds_read_b64 v[48:49], v51 offset:29184
    ds_read_u16 v50, v3 offset:1664
    s_waitcnt vmcnt(4)
    s_cmp_gt_u32 s19, 128
    s_cbranch_scc1 k2_rare32
k2_rareb32:
    s_waitcnt lgkmcnt(0)
    s_cmp_eq_u32 s20, 0
    s_cbranch_scc1 k2_pre_end33
    v_mov_b32 v51, 0x1010
    v_lshrrev_b32 v52, 8, v50
    v_and_b32 v48, 0xffff0000, v48
    v_and_b32 v49, 0xffff0000, v49
    ds_write_b16 v3, v51 offset:1664
    v_lshrrev_b32 v50, v50, s43
    v_lshrrev_b32 v52, v52, s43
    v_mul_f32 v53, 0.15915494, v48
    v_mul_f32 v55, 0x40400000, v48
    v_mul_f32 v56, 0.15915494, v49
    v_mul_f32 v58, 0x40400000, v49
    v_fract_f32 v53, v53
    v_cvt_pk_bf16_f32 v55, 0, v55
    v_fract_f32 v56, v56
    v_cvt_pk_bf16_f32 v58, 0, v58
    v_cos_f32 v53, v53
    v_mul_f32 v55, 0.15915494, v55
    v_cos_f32 v56, v56
    v_mul_f32 v58, 0.15915494, v58
    v_fract_f32 v55, v55
    v_fract_f32 v58, v58
    v_mul_f32 v54, v53, v53
    v_mul_f32 v57, v56, v56
    v_cos_f32 v55, v55
    v_cos_f32 v58, v58
    v_fma_f32 v54, 2.0, v54, -1.0
    v_fma_f32 v57, 2.0, v57, -1.0
    v_lshl_or_b32 v50, v52, 16, v50
    v_cvt_pk_bf16_f32 v53, v53, v56
    v_cvt_pk_bf16_f32 v55, v55, v58
    ds_write_b32 v1, v50 offset:960
    v_cvt_pk_bf16_f32 v54, v54, v57
    ds_write_b32 v1, v53 offset:0
    ds_write_b32 v1, v55 offset:640
    ds_write_b32 v1, v54 offset:320
    s_cmp_gt_u32 s20, 128
    s_cbranch_scc1 k2_pre2_33
k2_pre_end33:
    s_sub_u32 s42, s42, 128
    v_cmp_gt_i32 vcc, s42, v4
    v_lshl_add_u32 v19, v19, 5, v5
    s_mov_b64 exec, vcc
    buffer_load_dwordx4 v[44:47], v19, s[4:7], 0 offen
    s_mov_b64 exec, -1
    ds_read_b128 v[48:51], v2 offset:960
    ds_read_b128 v[52:55], v2 offset:0
    ds_read_b128 v[56:59], v2 offset:320
    s_waitcnt vmcnt(4)
    s_cmp_eq_u32 s38, 0
    s_cbranch_scc0 k2_lc34
k2_lc_end34:
    s_cmp_eq_u32 s37, 0
    s_cbranch_scc1 k2_nf35
    v_mov_b32 v10, 640
    v_mov_b32 v18, 1
    ds_write_b32 v10, v18
k2_nf35:
    s_waitcnt lgkmcnt(0)
    s_barrier
k2_entry:
    s_mov_b64 exec, 31
    v_lshl_add_u32 v10, v0, 2, s49
    v_mov_b32 v11, 0
    ds_read_b32 v18, v10 offset:0
    ds_write_b32 v10, v11 offset:0
    s_mov_b64 exec, -1
    v_add_u32 v4, s32, v4
    s_ashr_i32 s39, s32, 2
    s_add_u32 s31, s31, s32
    ds_read_u16 v19, v4 offset:26624
    v_add_u32 v3, s39, v3
    s_ashr_i32 s40, s32, 31
    s_sub_u32 s12, s12, s39
    s_subb_u32 s13, s13, s40
    s_sub_u32 s32, 0, s32
    s_xor_b32 s33, s33, 320
    s_add_u32 s49, s44, s33
    s_add_u32 s52, s52, 2097152
    s_addc_u32 s53, s53, 0
    s_mov_b32 s4, s52
    s_mov_b32 s5, s53
    s_add_u32 s39, s34, 1
    s_lshl_b32 s39, s39, 21
    s_sub_u32 s39, 10240000, s39
    s_max_i32 s39, s39, 0
    s_min_u32 s6, s39, 2097152
    s_add_u32 s60, s60, 1
    s_and_b32 s60, s60, 3
    s_cmp_lt_u32 s60, 2
    s_cbranch_scc1 k2_pr01_36
    s_cmp_eq_u32 s60, 2
    s_cbranch_scc1 k2_pr2_36
    s_setprio 3
    s_branch k2_prd_36
k2_pr2_36:
    s_setprio 2
    s_branch k2_prd_36
k2_pr01_36:
    s_cmp_eq_u32 s60, 0
    s_cbranch_scc1 k2_pr0_36
    s_setprio 1
    s_branch k2_prd_36
k2_pr0_36:
    s_setprio 0
k2_prd_36:
    s_cmp_le_u32 s20, 0
    s_cbranch_scc1 k2_skip37
    v_mfma_f32_16x16x32_bf16 v[60:63], v[28:31], v[20:23], 0
    v_mfma_f32_16x16x32_bf16 v[64:67], v[28:31], v[24:27], 0
    ds_read_b128 v[28:31], v2 offset:640
    v_pk_lshlrev_b16 v48, v0, v48 op_sel_hi:[0,1]
    v_pk_lshlrev_b16 v49, v0, v49 op_sel_hi:[0,1]
    v_pk_lshlrev_b16 v50, v0, v50 op_sel_hi:[0,1]
    v_pk_lshlrev_b16 v51, v0, v51 op_sel_hi:[0,1]
    v_pk_ashrrev_i16 v48, 15, v48 op_sel_hi:[0,1]
    v_pk_ashrrev_i16 v49, 15, v49 op_sel_hi:[0,1]
    v_pk_ashrrev_i16 v50, 15, v50 op_sel_hi:[0,1]
    v_pk_ashrrev_i16 v51, 15, v51 op_sel_hi:[0,1]
    s_nop 1
    v_cvt_pk_bf16_f32 v60, v60, v61
    v_cvt_pk_bf16_f32 v61, v62, v63
    v_cvt_pk_bf16_f32 v62, v64, v65
    v_cvt_pk_bf16_f32 v63, v66, v67
    v_and_b32 v52, v48, v52
    v_and_b32 v53, v49, v53
    v_and_b32 v54, v50, v54
    v_and_b32 v55, v51, v55
    v_and_b32 v56, v48, v56
    v_and_b32 v57, v49, v57
    v_and_b32 v58, v50, v58
    v_and_b32 v59, v51, v59
    v_mfma_f32_16x16x32_bf16 v[116:119], v[60:63], v[52:55], v[116:119]
    s_waitcnt lgkmcnt(0)
    v_and_b32 v28, v48, v28
    v_mfma_f32_16x16x32_bf16 v[120:123], v[60:63], v[56:59], v[120:123]
    v_and_b32 v29, v49, v29
    v_and_b32 v30, v50, v30
    v_and_b32 v31, v51, v31
    s_nop 1
    v_mfma_f32_16x16x32_bf16 v[124:127], v[60:63], v[28:31], v[124:127]
k2_skip37:
    s_waitcnt lgkmcnt(0)
    s_mov_b64 exec, 31
    v_cmp_lt_u32 vcc, 160, v18
    v_min_u32 v18, 160, v18
    s_mov_b64 exec, -1
    s_or_b32 s37, s37, vcc_lo
    v_readlane_b32 s21, v18, 0
    v_readlane_b32 s22, v18, 1
    v_readlane_b32 s23, v18, 2
    v_readlane_b32 s24, v18, 3
    v_readlane_b32 s25, v18, 4
    s_lshl2_add_u32 s42, s21, s31
    v_cmp_gt_i32 vcc, s42, v4
    v_lshl_add_u32 v19, v19, 5, v5
    s_mov_b64 exec, vcc
    buffer_load_dwordx4 v[28:31], v19, s[4:7], 0 offen
    s_mov_b64 exec, -1
    ds_read_u16 v19, v4 offset:26752
    ds_read_b128 v[48:51], v2 offset:1024
    ds_read_b128 v[52:55], v2 offset:64
    ds_read_b128 v[56:59], v2 offset:384
    v_lshrrev_b32 v66, 16, v6
    v_and_b32 v6, 0xffff, v6
    v_mul_u32_u24 v67, 655360, v0
    v_cmp_lt_u32 vcc, 63, v66
    v_add_u32 v6, v6, v67
    v_min_u32 v66, 63, v66
    v_add_u32 v6, s47, v6
    s_mov_b32 s38, vcc_lo
    v_lshl_or_b32 v6, v6, 7, v66
    s_nop 0
    v_readlane_b32 s39, v6, 0
    s_bfm_b64 s[66:67], s39, 0
    s_lshr_b32 s40, s39, 6
    s_mov_b64 exec, s[66:67]
    s_lshl_b32 s41, s40, 1
    buffer_load_ushort v12, v3, s[12:15], s40 offen
    buffer_load_dword v7, v1, s[8:11], s41 offen
    s_mov_b64 exec, -1
    s_waitcnt vmcnt(6)
    s_cmp_le_u32 s20, 32
    s_cbranch_scc1 k2_skip38
    v_mfma_f32_16x16x32_bf16 v[60:63], v[32:35], v[20:23], 0
    v_mfma_f32_16x16x32_bf16 v[64:67], v[32:35], v[24:27], 0
    ds_read_b128 v[32:35], v2 offset:704
    s_waitcnt lgkmcnt(3)
    v_pk_lshlrev_b16 v48, v0, v48 op_sel_hi:[0,1]
    v_pk_lshlrev_b16 v49, v0, v49 op_sel_hi:[0,1]
    v_pk_lshlrev_b16 v50, v0, v50 op_sel_hi:[0,1]
    v_pk_lshlrev_b16 v51, v0, v51 op_sel_hi:[0,1]
    v_pk_ashrrev_i16 v48, 15, v48 op_sel_hi:[0,1]
    v_pk_ashrrev_i16 v49, 15, v49 op_sel_hi:[0,1]
    v_pk_ashrrev_i16 v50, 15, v50 op_sel_hi:[0,1]
    v_pk_ashrrev_i16 v51, 15, v51 op_sel_hi:[0,1]
    s_nop 1
    v_cvt_pk_bf16_f32 v60, v60, v61
    v_cvt_pk_bf16_f32 v61, v62, v63
    v_cvt_pk_bf16_f32 v62, v64, v65
    v_cvt_pk_bf16_f32 v63, v66, v67
    s_waitcnt lgkmcnt(1)
    v_and_b32 v52, v48, v52
    v_and_b32 v53, v49, v53
    v_and_b32 v54, v50, v54
    v_and_b32 v55, v51, v55
    v_and_b32 v56, v48, v56
    v_and_b32 v57, v49, v57
    v_and_b32 v58, v50, v58
    v_and_b32 v59, v51, v59
    v_mfma_f32_16x16x32_bf16 v[116:119], v[60:63], v[52:55], v[116:119]
    s_waitcnt lgkmcnt(0)
    v_and_b32 v32, v48, v32
    v_mfma_f32_16x16x32_bf16 v[120:123], v[60:63], v[56:59], v[120:123]
    v_and_b32 v33, v49, v33
    v_and_b32 v34, v50, v34
    v_and_b32 v35, v51, v35
    s_nop 1
    v_mfma_f32_16x16x32_bf16 v[124:127], v[60:63], v[32:35], v[124:127]
k2_skip38:
    s_waitcnt lgkmcnt(3)
    s_sub_u32 s42, s42, 128
    v_cmp_gt_i32 vcc, s42, v4
    v_lshl_add_u32 v19, v19, 5, v5
    s_mov_b64 exec, vcc
    buffer_load_dwordx4 v[32:35], v19, s[4:7], 0 offen
    s_mov_b64 exec, -1
    ds_read_u16 v19, v4 offset:26880
    ds_read_b128 v[48:51], v2 offset:1088
    ds_read_b128 v[52:55], v2 offset:128
    ds_read_b128 v[56:59], v2 offset:448
    v_readlane_b32 s39, v6, 1
    s_bfm_b64 s[68:69], s39, 0
    s_lshr_b32 s40, s39, 6
    s_mov_b64 exec, s[68:69]
    s_lshl_b32 s41, s40, 1
    buffer_load_ushort v13, v3, s[12:15], s40 offen
    buffer_load_dword v8, v1, s[8:11], s41 offen
    s_mov_b64 exec, -1
    s_waitcnt vmcnt(8)
    s_add_u32 s60, s60, 1
    s_and_b32 s60, s60, 3
    s_cmp_lt_u32 s60, 2
    s_cbranch_scc1 k2_pr01_39
    s_cmp_eq_u32 s60, 2
    s_cbranch_scc1 k2_pr2_39
    s_setprio 3
    s_branch k2_prd_39
k2_pr2_39:
    s_setprio 2
    s_branch k2_prd_39
k2_pr01_39:
    s_cmp_eq_u32 s60, 0
    s_cbranch_scc1 k2_pr0_39
    s_setprio 1
    s_branch k2_prd_39
k2_pr0_39:
    s_setprio 0
k2_prd_39:
    s_cmp_le_u32 s20, 64
    s_cbranch_scc1 k2_skip40
    v_mfma_f32_16x16x32_bf16 v[60:63], v[36:39], v[20:23], 0
    v_mfma_f32_16x16x32_bf16 v[64:67], v[36:39], v[24:27], 0
    ds_read_b128 v[36:39], v2 offset:768
    s_waitcnt lgkmcnt(3)
    v_pk_lshlrev_b16 v48, v0, v48 op_sel_hi:[0,1]
    v_pk_lshlrev_b16 v49, v0, v49 op_sel_hi:[0,1]
    v_pk_lshlrev_b16 v50, v0, v50 op_sel_hi:[0,1]
    v_pk_lshlrev_b16 v51, v0, v51 op_sel_hi:[0,1]
    v_pk_ashrrev_i16 v48, 15, v48 op_sel_hi:[0,1]
    v_pk_ashrrev_i16 v49, 15, v49 op_sel_hi:[0,1]
    v_pk_ashrrev_i16 v50, 15, v50 op_sel_hi:[0,1]
    v_pk_ashrrev_i16 v51, 15, v51 op_sel_hi:[0,1]
    s_nop 1
    v_cvt_pk_bf16_f32 v60, v60, v61
    v_cvt_pk_bf16_f32 v61, v62, v63
    v_cvt_pk_bf16_f32 v62, v64, v65
    v_cvt_pk_bf16_f32 v63, v66, v67
    s_waitcnt lgkmcnt(1)
    v_and_b32 v52, v48, v52
    v_and_b32 v53, v49, v53
    v_and_b32 v54, v50, v54
    v_and_b32 v55, v51, v55
    v_and_b32 v56, v48, v56
    v_and_b32 v57, v49, v57
    v_and_b32 v58, v50, v58
    v_and_b32 v59, v51, v59
    v_mfma_f32_16x16x32_bf16 v[116:119], v[60:63], v[52:55], v[116:119]
    s_waitcnt lgkmcnt(0)
    v_and_b32 v36, v48, v36
    v_mfma_f32_16x16x32_bf16 v[120:123], v[60:63], v[56:59], v[120:123]
    v_and_b32 v37, v49, v37
    v_and_b32 v38, v50, v38
    v_and_b32 v39, v51, v39
    s_nop 1
    v_mfma_f32_16x16x32_bf16 v[124:127], v[60:63], v[36:39], v[124:127]
k2_skip40:
    s_waitcnt lgkmcnt(3)
    s_sub_u32 s42, s42, 128
    v_cmp_gt_i32 vcc, s42, v4
    v_lshl_add_u32 v19, v19, 5, v5
    s_mov_b64 exec, vcc
    buffer_load_dwordx4 v[36:39], v19, s[4:7], 0 offen
    s_mov_b64 exec, -1
    ds_read_u16 v19, v4 offset:27008
    ds_read_b128 v[48:51], v2 offset:1152
    ds_read_b128 v[52:55], v2 offset:192
    ds_read_b128 v[56:59], v2 offset:512
    v_readlane_b32 s39, v6, 2
    s_bfm_b64 s[70:71], s39, 0
    s_lshr_b32 s40, s39, 6
    s_mov_b64 exec, s[70:71]
    s_lshl_b32 s41, s40, 1
    buffer_load_ushort v14, v3, s[12:15], s40 offen
    buffer_load_dword v9, v1, s[8:11], s41 offen
    s_mov_b64 exec, -1
    s_waitcnt vmcnt(10)
    s_cmp_le_u32 s20, 96
    s_cbranch_scc1 k2_skip41
    v_mfma_f32_16x16x32_bf16 v[60:63], v[40:43], v[20:23], 0
    v_mfma_f32_16x16x32_bf16 v[64:67], v[40:43], v[24:27], 0
    ds_read_b128 v[40:43], v2 offset:832
    s_waitcnt lgkmcnt(3)
    v_pk_lshlrev_b16 v48, v0, v48 op_sel_hi:[0,1]
    v_pk_lshlrev_b16 v49, v0, v49 op_sel_hi:[0,1]
    v_pk_lshlrev_b16 v50, v0, v50 op_sel_hi:[0,1]
    v_pk_lshlrev_b16 v51, v0, v51 op_sel_hi:[0,1]
    v_pk_ashrrev_i16 v48, 15, v48 op_sel_hi:[0,1]
    v_pk_ashrrev_i16 v49, 15, v49 op_sel_hi:[0,1]
    v_pk_ashrrev_i16 v50, 15, v50 op_sel_hi:[0,1]
    v_pk_ashrrev_i16 v51, 15, v51 op_sel_hi:[0,1]
    s_nop 1
    v_cvt_pk_bf16_f32 v60, v60, v61
    v_cvt_pk_bf16_f32 v61, v62, v63
    v_cvt_pk_bf16_f32 v62, v64, v65
    v_cvt_pk_bf16_f32 v63, v66, v67
    s_waitcnt lgkmcnt(1)
    v_and_b32 v52, v48, v52
    v_and_b32 v53, v49, v53
    v_and_b32 v54, v50, v54
    v_and_b32 v55, v51, v55
    v_and_b32 v56, v48, v56
    v_and_b32 v57, v49, v57
    v_and_b32 v58, v50, v58
    v_and_b32 v59, v51, v59
    v_mfma_f32_16x16x32_bf16 v[116:119], v[60:63], v[52:55], v[116:119]
    s_waitcnt lgkmcnt(0)
    v_and_b32 v40, v48, v40
    v_mfma_f32_16x16x32_bf16 v[120:123], v[60:63], v[56:59], v[120:123]
    v_and_b32 v41, v49, v41
    v_and_b32 v42, v50, v42
    v_and_b32 v43, v51, v43
    s_nop 1
    v_mfma_f32_16x16x32_bf16 v[124:127], v[60:63], v[40:43], v[124:127]
k2_skip41:
    s_waitcnt lgkmcnt(3)
    s_sub_u32 s42, s42, 128
    v_cmp_gt_i32 vcc, s42, v4
    v_lshl_add_u32 v19, v19, 5, v5
    s_mov_b64 exec, vcc
    buffer_load_dwordx4 v[40:43], v19, s[4:7], 0 offen
    s_mov_b64 exec, -1
    ds_read_u16 v19, v4 offset:27136
    v_lshlrev_b32 v51, 2, v3
    ds_read_b64 v[48:49], v51 offset:26624
    ds_read_u16 v50, v3 offset:1024
    v_readlane_b32 s39, v6, 3
    s_bfm_b64 s[72:73], s39, 0
    s_lshr_b32 s40, s39, 6
    s_mov_b64 exec, s[72:73]
    s_lshl_b32 s41, s40, 1
    buffer_load_ushort v15, v3, s[12:15], s40 offen
    buffer_load_dword v10, v1, s[8:11], s41 offen
    s_mov_b64 exec, -1
    s_waitcnt vmcnt(12)
    s_cmp_gt_u32 s20, 128
    s_cbranch_scc1 k2_rare42
k2_rareb42:
    s_waitcnt lgkmcnt(0)
    s_cmp_eq_u32 s21, 0
    s_cbranch_scc1 k2_pre_end43
    v_mov_b32 v51, 0x1010
    v_lshrrev_b32 v52, 8, v50
    v_and_b32 v48, 0xffff0000, v48
    v_and_b32 v49, 0xffff0000, v49
    ds_write_b16 v3, v51 offset:1024
    v_lshrrev_b32 v50, v50, s43
    v_lshrrev_b32 v52, v52, s43
    v_mul_f32 v53, 0.15915494, v48
    v_mul_f32 v55, 0x40400000, v48
    v_mul_f32 v56, 0.15915494, v49
    v_mul_f32 v58, 0x40400000, v49
    v_fract_f32 v53, v53
    v_cvt_pk_bf16_f32 v55, 0, v55
    v_fract_f32 v56, v56
    v_cvt_pk_bf16_f32 v58, 0, v58
    v_cos_f32 v53, v53
    v_mul_f32 v55, 0.15915494, v55
    v_cos_f32 v56, v56
    v_mul_f32 v58, 0.15915494, v58
    v_fract_f32 v55, v55
    v_fract_f32 v58, v58
    v_mul_f32 v54, v53, v53
    v_mul_f32 v57, v56, v56
    v_cos_f32 v55, v55
    v_cos_f32 v58, v58
    v_fma_f32 v54, 2.0, v54, -1.0
    v_fma_f32 v57, 2.0, v57, -1.0
    v_lshl_or_b32 v50, v52, 16, v50
    v_cvt_pk_bf16_f32 v53, v53, v56
    v_cvt_pk_bf16_f32 v55, v55, v58
    ds_write_b32 v1, v50 offset:960
    v_cvt_pk_bf16_f32 v54, v54, v57
    ds_write_b32 v1, v53 offset:0
    ds_write_b32 v1, v55 offset:640
    ds_write_b32 v1, v54 offset:320
    s_cmp_gt_u32 s21, 128
    s_cbranch_scc1 k2_pre2_43
k2_pre_end43:
    s_sub_u32 s42, s42, 128
    v_cmp_gt_i32 vcc, s42, v4
    v_lshl_add_u32 v19, v19, 5, v5
    s_mov_b64 exec, vcc
    buffer_load_dwordx4 v[44:47], v19, s[4:7], 0 offen
    s_mov_b64 exec, -1
    ds_read_u16 v19, v4 offset:27264
    ds_read_b128 v[48:51], v2 offset:960
    ds_read_b128 v[52:55], v2 offset:0
    ds_read_b128 v[56:59], v2 offset:320
    v_readlane_b32 s39, v6, 4
    s_bfm_b64 s[74:75], s39, 0
    s_lshr_b32 s40, s39, 6
    s_mov_b64 exec, s[74:75]
    s_lshl_b32 s41, s40, 1
    buffer_load_ushort v16, v3, s[12:15], s40 offen
    buffer_load_dword v11, v1, s[8:11], s41 offen
    s_mov_b64 exec, -1
    s_mov_b32 s16, s21
    s_mov_b32 s17, s22
    s_mov_b32 s18, s23
    s_mov_b32 s19, s24
    s_mov_b32 s20, s25
    s_add_u32 s34, s34, 1
    s_cmp_lt_i32 s34, 4
    s_cbranch_scc1 k2_loop
    s_waitcnt vmcnt(12)
    s_add_u32 s60, s60, 1
    s_and_b32 s60, s60, 3
    s_cmp_lt_u32 s60, 2
    s_cbranch_scc1 k2_pr01_44
    s_cmp_eq_u32 s60, 2
    s_cbranch_scc1 k2_pr2_44
    s_setprio 3
    s_branch k2_prd_44
k2_pr2_44:
    s_setprio 2
    s_branch k2_prd_44
k2_pr01_44:
    s_cmp_eq_u32 s60, 0
    s_cbranch_scc1 k2_pr0_44
    s_setprio 1
    s_branch k2_prd_44
k2_pr0_44:
    s_setprio 0
k2_prd_44:
    s_cmp_le_u32 s16, 0
    s_cbranch_scc1 k2_skip45
    v_mfma_f32_16x16x32_bf16 v[60:63], v[28:31], v[20:23], 0
    v_mfma_f32_16x16x32_bf16 v[64:67], v[28:31], v[24:27], 0
    ds_read_b128 v[28:31], v2 offset:640
    s_waitcnt lgkmcnt(3)
    v_pk_lshlrev_b16 v48, v0, v48 op_sel_hi:[0,1]
    v_pk_lshlrev_b16 v49, v0, v49 op_sel_hi:[0,1]
    v_pk_lshlrev_b16 v50, v0, v50 op_sel_hi:[0,1]
    v_pk_lshlrev_b16 v51, v0, v51 op_sel_hi:[0,1]
    v_pk_ashrrev_i16 v48, 15, v48 op_sel_hi:[0,1]
    v_pk_ashrrev_i16 v49, 15, v49 op_sel_hi:[0,1]
    v_pk_ashrrev_i16 v50, 15, v50 op_sel_hi:[0,1]
    v_pk_ashrrev_i16 v51, 15, v51 op_sel_hi:[0,1]
    s_nop 1
    v_cvt_pk_bf16_f32 v60, v60, v61
    v_cvt_pk_bf16_f32 v61, v62, v63
    v_cvt_pk_bf16_f32 v62, v64, v65
    v_cvt_pk_bf16_f32 v63, v66, v67
    s_waitcnt lgkmcnt(1)
    v_and_b32 v52, v48, v52
    v_and_b32 v53, v49, v53
    v_and_b32 v54, v50, v54
    v_and_b32 v55, v51, v55
    v_and_b32 v56, v48, v56
    v_and_b32 v57, v49, v57
    v_and_b32 v58, v50, v58
    v_and_b32 v59, v51, v59
    v_mfma_f32_16x16x32_bf16 v[68:71], v[60:63], v[52:55], v[68:71]
    s_waitcnt lgkmcnt(0)
    v_and_b32 v28, v48, v28
    v_mfma_f32_16x16x32_bf16 v[72:75], v[60:63], v[56:59], v[72:75]
    v_and_b32 v29, v49, v29
    v_and_b32 v30, v50, v30
    v_and_b32 v31, v51, v31
    s_nop 1
    v_mfma_f32_16x16x32_bf16 v[76:79], v[60:63], v[28:31], v[76:79]
k2_skip45:
    s_waitcnt lgkmcnt(3)
    s_lshl2_add_u32 s42, s17, s31
    v_cmp_gt_i32 vcc, s42, v4
    v_lshl_add_u32 v19, v19, 5, v5
    s_mov_b64 exec, vcc
    buffer_load_dwordx4 v[28:31], v19, s[4:7], 0 offen
    s_mov_b64 exec, -1
    ds_read_u16 v19, v4 offset:27392
    ds_read_b128 v[48:51], v2 offset:1024
    ds_read_b128 v[52:55], v2 offset:64
    ds_read_b128 v[56:59], v2 offset:384
    s_waitcnt vmcnt(10)
    v_and_b32 v6, 15, v0
    s_mul_i32 s39, s35, 160
    s_add_u32 s39, s39, 153088
    v_lshl_add_u32 v6, v6, 1, s39
    v_lshlrev_b32 v7, 4, v0
    v_add_u32 v7, 152064, v7
    ds_read_b128 v[12:15], v7
    s_mul_i32 s39, s35, 2560
    s_add_u32 s39, s39, 77824
    v_lshl_add_u32 v7, v0, 3, s39
    ds_read_u16 v16, v6 offset:0
    s_mov_b32 s40, 0xc1200000
    s_mov_b32 s41, 0x3fb8aa3b
    s_waitcnt lgkmcnt(0)
    v_lshlrev_b32 v16, 16, v16
    v_sub_f32 v8, v16, v12
    v_sub_f32 v9, v16, v13
    v_sub_f32 v10, v16, v14
    v_sub_f32 v11, v16, v15
    v_cvt_pk_bf16_f32 v8, 0, v8
    v_cvt_pk_bf16_f32 v9, 0, v9
    v_cvt_pk_bf16_f32 v10, 0, v10
    v_cvt_pk_bf16_f32 v11, 0, v11
    v_mul_f32 v8, v8, v8
    v_mul_f32 v9, v9, v9
    v_mul_f32 v10, v10, v10
    v_mul_f32 v11, v11, v11
    v_cvt_pk_bf16_f32 v8, 0, v8
    v_cvt_pk_bf16_f32 v9, 0, v9
    v_cvt_pk_bf16_f32 v10, 0, v10
    v_cvt_pk_bf16_f32 v11, 0, v11
    v_mul_f32 v8, s40, v8
    v_mul_f32 v9, s40, v9
    v_mul_f32 v10, s40, v10
    v_mul_f32 v11, s40, v11
    v_cvt_pk_bf16_f32 v8, 0, v8
    v_cvt_pk_bf16_f32 v9, 0, v9
    v_cvt_pk_bf16_f32 v10, 0, v10
    v_cvt_pk_bf16_f32 v11, 0, v11
    v_mul_f32 v8, s41, v8
    v_mul_f32 v9, s41, v9
    v_mul_f32 v10, s41, v10
    v_mul_f32 v11, s41, v11
    v_exp_f32 v8, v8
    v_exp_f32 v9, v9
    v_exp_f32 v10, v10
    v_exp_f32 v11, v11
    s_nop 0
    v_cvt_pk_bf16_f32 v16, v8, v9
    v_cvt_pk_bf16_f32 v17, v10, v11
    ds_write_b64 v7, v[16:17] offset:0
    s_cmp_le_u32 s16, 32
    s_cbranch_scc1 k2_skip46
    v_mfma_f32_16x16x32_bf16 v[60:63], v[32:35], v[20:23], 0
    v_mfma_f32_16x16x32_bf16 v[64:67], v[32:35], v[24:27], 0
    ds_read_b128 v[32:35], v2 offset:704
    s_waitcnt lgkmcnt(3)
    v_pk_lshlrev_b16 v48, v0, v48 op_sel_hi:[0,1]
    v_pk_lshlrev_b16 v49, v0, v49 op_sel_hi:[0,1]
    v_pk_lshlrev_b16 v50, v0, v50 op_sel_hi:[0,1]
    v_pk_lshlrev_b16 v51, v0, v51 op_sel_hi:[0,1]
    v_pk_ashrrev_i16 v48, 15, v48 op_sel_hi:[0,1]
    v_pk_ashrrev_i16 v49, 15, v49 op_sel_hi:[0,1]
    v_pk_ashrrev_i16 v50, 15, v50 op_sel_hi:[0,1]
    v_pk_ashrrev_i16 v51, 15, v51 op_sel_hi:[0,1]
    s_nop 1
    v_cvt_pk_bf16_f32 v60, v60, v61
    v_cvt_pk_bf16_f32 v61, v62, v63
    v_cvt_pk_bf16_f32 v62, v64, v65
    v_cvt_pk_bf16_f32 v63, v66, v67
    s_waitcnt lgkmcnt(1)
    v_and_b32 v52, v48, v52
    v_and_b32 v53, v49, v53
    v_and_b32 v54, v50, v54
    v_and_b32 v55, v51, v55
    v_and_b32 v56, v48, v56
    v_and_b32 v57, v49, v57
    v_and_b32 v58, v50, v58
    v_and_b32 v59, v51, v59
    v_mfma_f32_16x16x32_bf16 v[68:71], v[60:63], v[52:55], v[68:71]
    s_waitcnt lgkmcnt(0)
    v_and_b32 v32, v48, v32
    v_mfma_f32_16x16x32_bf16 v[72:75], v[60:63], v[56:59], v[72:75]
    v_and_b32 v33, v49, v33
    v_and_b32 v34, v50, v34
    v_and_b32 v35, v51, v35
    s_nop 1
    v_mfma_f32_16x16x32_bf16 v[76:79], v[60:63], v[32:35], v[76:79]
k2_skip46:
    s_waitcnt lgkmcnt(3)
    s_sub_u32 s42, s42, 128
    v_cmp_gt_i32 vcc, s42, v4
    v_lshl_add_u32 v19, v19, 5, v5
    s_mov_b64 exec, vcc
    buffer_load_dwordx4 v[32:35], v19, s[4:7], 0 offen
    s_mov_b64 exec, -1
    ds_read_u16 v19, v4 offset:27520
    ds_read_b128 v[48:51], v2 offset:1088
    ds_read_b128 v[52:55], v2 offset:128
    ds_read_b128 v[56:59], v2 offset:448
    s_waitcnt vmcnt(8)
    ds_read_u16 v16, v6 offset:32
    s_mov_b32 s40, 0xc1200000
    s_mov_b32 s41, 0x3fb8aa3b
    s_waitcnt lgkmcnt(0)
    v_lshlrev_b32 v16, 16, v16
    v_sub_f32 v8, v16, v12
    v_sub_f32 v9, v16, v13
    v_sub_f32 v10, v16, v14
    v_sub_f32 v11, v16, v15
    v_cvt_pk_bf16_f32 v8, 0, v8
    v_cvt_pk_bf16_f32 v9, 0, v9
    v_cvt_pk_bf16_f32 v10, 0, v10
    v_cvt_pk_bf16_f32 v11, 0, v11
    v_mul_f32 v8, v8, v8
    v_mul_f32 v9, v9, v9
    v_mul_f32 v10, v10, v10
    v_mul_f32 v11, v11, v11
    v_cvt_pk_bf16_f32 v8, 0, v8
    v_cvt_pk_bf16_f32 v9, 0, v9
    v_cvt_pk_bf16_f32 v10, 0, v10
    v_cvt_pk_bf16_f32 v11, 0, v11
    v_mul_f32 v8, s40, v8
    v_mul_f32 v9, s40, v9
    v_mul_f32 v10, s40, v10
    v_mul_f32 v11, s40, v11
    v_cvt_pk_bf16_f32 v8, 0, v8
    v_cvt_pk_bf16_f32 v9, 0, v9
    v_cvt_pk_bf16_f32 v10, 0, v10
    v_cvt_pk_bf16_f32 v11, 0, v11
    v_mul_f32 v8, s41, v8
    v_mul_f32 v9, s41, v9
    v_mul_f32 v10, s41, v10
    v_mul_f32 v11, s41, v11
    v_exp_f32 v8, v8
    v_exp_f32 v9, v9
    v_exp_f32 v10, v10
    v_exp_f32 v11, v11
    s_nop 0
    v_cvt_pk_bf16_f32 v16, v8, v9
    v_cvt_pk_bf16_f32 v17, v10, v11
    ds_write_b64 v7, v[16:17] offset:512
    s_add_u32 s60, s60, 1
    s_and_b32 s60, s60, 3
    s_cmp_lt_u32 s60, 2
    s_cbranch_scc1 k2_pr01_47
    s_cmp_eq_u32 s60, 2
    s_cbranch_scc1 k2_pr2_47
    s_setprio 3
    s_branch k2_prd_47
k2_pr2_47:
    s_setprio 2
    s_branch k2_prd_47
k2_pr01_47:
    s_cmp_eq_u32 s60, 0
    s_cbranch_scc1 k2_pr0_47
    s_setprio 1
    s_branch k2_prd_47
k2_pr0_47:
    s_setprio 0
k2_prd_47:
    s_cmp_le_u32 s16, 64
    s_cbranch_scc1 k2_skip48
    v_mfma_f32_16x16x32_bf16 v[60:63], v[36:39], v[20:23], 0
    v_mfma_f32_16x16x32_bf16 v[64:67], v[36:39], v[24:27], 0
    ds_read_b128 v[36:39], v2 offset:768
    s_waitcnt lgkmcnt(3)
    v_pk_lshlrev_b16 v48, v0, v48 op_sel_hi:[0,1]
    v_pk_lshlrev_b16 v49, v0, v49 op_sel_hi:[0,1]
    v_pk_lshlrev_b16 v50, v0, v50 op_sel_hi:[0,1]
    v_pk_lshlrev_b16 v51, v0, v51 op_sel_hi:[0,1]
    v_pk_ashrrev_i16 v48, 15, v48 op_sel_hi:[0,1]
    v_pk_ashrrev_i16 v49, 15, v49 op_sel_hi:[0,1]
    v_pk_ashrrev_i16 v50, 15, v50 op_sel_hi:[0,1]
    v_pk_ashrrev_i16 v51, 15, v51 op_sel_hi:[0,1]
    s_nop 1
    v_cvt_pk_bf16_f32 v60, v60, v61
    v_cvt_pk_bf16_f32 v61, v62, v63
    v_cvt_pk_bf16_f32 v62, v64, v65
    v_cvt_pk_bf16_f32 v63, v66, v67
    s_waitcnt lgkmcnt(1)
    v_and_b32 v52, v48, v52
    v_and_b32 v53, v49, v53
    v_and_b32 v54, v50, v54
    v_and_b32 v55, v51, v55
    v_and_b32 v56, v48, v56
    v_and_b32 v57, v49, v57
    v_and_b32 v58, v50, v58
    v_and_b32 v59, v51, v59
    v_mfma_f32_16x16x32_bf16 v[68:71], v[60:63], v[52:55], v[68:71]
    s_waitcnt lgkmcnt(0)
    v_and_b32 v36, v48, v36
    v_mfma_f32_16x16x32_bf16 v[72:75], v[60:63], v[56:59], v[72:75]
    v_and_b32 v37, v49, v37
    v_and_b32 v38, v50, v38
    v_and_b32 v39, v51, v39
    s_nop 1
    v_mfma_f32_16x16x32_bf16 v[76:79], v[60:63], v[36:39], v[76:79]
k2_skip48:
    s_waitcnt lgkmcnt(3)
    s_sub_u32 s42, s42, 128
    v_cmp_gt_i32 vcc, s42, v4
    v_lshl_add_u32 v19, v19, 5, v5
    s_mov_b64 exec, vcc
    buffer_load_dwordx4 v[36:39], v19, s[4:7], 0 offen
    s_mov_b64 exec, -1
    ds_read_u16 v19, v4 offset:27648
    ds_read_b128 v[48:51], v2 offset:1152
    ds_read_b128 v[52:55], v2 offset:192
    ds_read_b128 v[56:59], v2 offset:512
    s_waitcnt vmcnt(6)
    ds_read_u16 v16, v6 offset:64
    s_mov_b32 s40, 0xc1200000
    s_mov_b32 s41, 0x3fb8aa3b
    s_waitcnt lgkmcnt(0)
    v_lshlrev_b32 v16, 16, v16
    v_sub_f32 v8, v16, v12
    v_sub_f32 v9, v16, v13
    v_sub_f32 v10, v16, v14
    v_sub_f32 v11, v16, v15
    v_cvt_pk_bf16_f32 v8, 0, v8
    v_cvt_pk_bf16_f32 v9, 0, v9
    v_cvt_pk_bf16_f32 v10, 0, v10
    v_cvt_pk_bf16_f32 v11, 0, v11
    v_mul_f32 v8, v8, v8
    v_mul_f32 v9, v9, v9
    v_mul_f32 v10, v10, v10
    v_mul_f32 v11, v11, v11
    v_cvt_pk_bf16_f32 v8, 0, v8
    v_cvt_pk_bf16_f32 v9, 0, v9
    v_cvt_pk_bf16_f32 v10, 0, v10
    v_cvt_pk_bf16_f32 v11, 0, v11
    v_mul_f32 v8, s40, v8
    v_mul_f32 v9, s40, v9
    v_mul_f32 v10, s40, v10
    v_mul_f32 v11, s40, v11
    v_cvt_pk_bf16_f32 v8, 0, v8
    v_cvt_pk_bf16_f32 v9, 0, v9
    v_cvt_pk_bf16_f32 v10, 0, v10
    v_cvt_pk_bf16_f32 v11, 0, v11
    v_mul_f32 v8, s41, v8
    v_mul_f32 v9, s41, v9
    v_mul_f32 v10, s41, v10
    v_mul_f32 v11, s41, v11
    v_exp_f32 v8, v8
    v_exp_f32 v9, v9
    v_exp_f32 v10, v10
    v_exp_f32 v11, v11
    s_nop 0
    v_cvt_pk_bf16_f32 v16, v8, v9
    v_cvt_pk_bf16_f32 v17, v10, v11
    ds_write_b64 v7, v[16:17] offset:1024
    s_cmp_le_u32 s16, 96
    s_cbranch_scc1 k2_skip49
    v_mfma_f32_16x16x32_bf16 v[60:63], v[40:43], v[20:23], 0
    v_mfma_f32_16x16x32_bf16 v[64:67], v[40:43], v[24:27], 0
    ds_read_b128 v[40:43], v2 offset:832
    s_waitcnt lgkmcnt(3)
    v_pk_lshlrev_b16 v48, v0, v48 op_sel_hi:[0,1]
    v_pk_lshlrev_b16 v49, v0, v49 op_sel_hi:[0,1]
    v_pk_lshlrev_b16 v50, v0, v50 op_sel_hi:[0,1]
    v_pk_lshlrev_b16 v51, v0, v51 op_sel_hi:[0,1]
    v_pk_ashrrev_i16 v48, 15, v48 op_sel_hi:[0,1]
    v_pk_ashrrev_i16 v49, 15, v49 op_sel_hi:[0,1]
    v_pk_ashrrev_i16 v50, 15, v50 op_sel_hi:[0,1]
    v_pk_ashrrev_i16 v51, 15, v51 op_sel_hi:[0,1]
    s_nop 1
    v_cvt_pk_bf16_f32 v60, v60, v61
    v_cvt_pk_bf16_f32 v61, v62, v63
    v_cvt_pk_bf16_f32 v62, v64, v65
    v_cvt_pk_bf16_f32 v63, v66, v67
    s_waitcnt lgkmcnt(1)
    v_and_b32 v52, v48, v52
    v_and_b32 v53, v49, v53
    v_and_b32 v54, v50, v54
    v_and_b32 v55, v51, v55
    v_and_b32 v56, v48, v56
    v_and_b32 v57, v49, v57
    v_and_b32 v58, v50, v58
    v_and_b32 v59, v51, v59
    v_mfma_f32_16x16x32_bf16 v[68:71], v[60:63], v[52:55], v[68:71]
    s_waitcnt lgkmcnt(0)
    v_and_b32 v40, v48, v40
    v_mfma_f32_16x16x32_bf16 v[72:75], v[60:63], v[56:59], v[72:75]
    v_and_b32 v41, v49, v41
    v_and_b32 v42, v50, v42
    v_and_b32 v43, v51, v43
    s_nop 1
    v_mfma_f32_16x16x32_bf16 v[76:79], v[60:63], v[40:43], v[76:79]
k2_skip49:
    s_waitcnt lgkmcnt(3)
    s_sub_u32 s42, s42, 128
    v_cmp_gt_i32 vcc, s42, v4
    v_lshl_add_u32 v19, v19, 5, v5
    s_mov_b64 exec, vcc
    buffer_load_dwordx4 v[40:43], v19, s[4:7], 0 offen
    s_mov_b64 exec, -1
    ds_read_u16 v19, v4 offset:27776
    v_lshlrev_b32 v51, 2, v3
    ds_read_b64 v[48:49], v51 offset:27264
    ds_read_u16 v50, v3 offset:1184
    s_waitcnt vmcnt(4)
    ds_read_u16 v16, v6 offset:96
    s_mov_b32 s40, 0xc1200000
    s_mov_b32 s41, 0x3fb8aa3b
    s_waitcnt lgkmcnt(0)
    v_lshlrev_b32 v16, 16, v16
    v_sub_f32 v8, v16, v12
    v_sub_f32 v9, v16, v13
    v_sub_f32 v10, v16, v14
    v_sub_f32 v11, v16, v15
    v_cvt_pk_bf16_f32 v8, 0, v8
    v_cvt_pk_bf16_f32 v9, 0, v9
    v_cvt_pk_bf16_f32 v10, 0, v10
    v_cvt_pk_bf16_f32 v11, 0, v11
    v_mul_f32 v8, v8, v8
    v_mul_f32 v9, v9, v9
    v_mul_f32 v10, v10, v10
    v_mul_f32 v11, v11, v11
    v_cvt_pk_bf16_f32 v8, 0, v8
    v_cvt_pk_bf16_f32 v9, 0, v9
    v_cvt_pk_bf16_f32 v10, 0, v10
    v_cvt_pk_bf16_f32 v11, 0, v11
    v_mul_f32 v8, s40, v8
    v_mul_f32 v9, s40, v9
    v_mul_f32 v10, s40, v10
    v_mul_f32 v11, s40, v11
    v_cvt_pk_bf16_f32 v8, 0, v8
    v_cvt_pk_bf16_f32 v9, 0, v9
    v_cvt_pk_bf16_f32 v10, 0, v10
    v_cvt_pk_bf16_f32 v11, 0, v11
    v_mul_f32 v8, s41, v8
    v_mul_f32 v9, s41, v9
    v_mul_f32 v10, s41, v10
    v_mul_f32 v11, s41, v11
    v_exp_f32 v8, v8
    v_exp_f32 v9, v9
    v_exp_f32 v10, v10
    v_exp_f32 v11, v11
    s_nop 0
    v_cvt_pk_bf16_f32 v16, v8, v9
    v_cvt_pk_bf16_f32 v17, v10, v11
    ds_write_b64 v7, v[16:17] offset:1536
    s_cmp_gt_u32 s16, 128
    s_cbranch_scc1 k2_rare50
k2_rareb50:
    s_waitcnt lgkmcnt(0)
    s_cmp_eq_u32 s17, 0
    s_cbranch_scc1 k2_pre_end51
    v_mov_b32 v51, 0x1010
    v_lshrrev_b32 v52, 8, v50
    v_and_b32 v48, 0xffff0000, v48
    v_and_b32 v49, 0xffff0000, v49
    ds_write_b16 v3, v51 offset:1184
    v_lshrrev_b32 v50, v50, s43
    v_lshrrev_b32 v52, v52, s43
    v_mul_f32 v53, 0.15915494, v48
    v_mul_f32 v55, 0x40400000, v48
    v_mul_f32 v56, 0.15915494, v49
    v_mul_f32 v58, 0x40400000, v49
    v_fract_f32 v53, v53
    v_cvt_pk_bf16_f32 v55, 0, v55
    v_fract_f32 v56, v56
    v_cvt_pk_bf16_f32 v58, 0, v58
    v_cos_f32 v53, v53
    v_mul_f32 v55, 0.15915494, v55
    v_cos_f32 v56, v56
    v_mul_f32 v58, 0.15915494, v58
    v_fract_f32 v55, v55
    v_fract_f32 v58, v58
    v_mul_f32 v54, v53, v53
    v_mul_f32 v57, v56, v56
    v_cos_f32 v55, v55
    v_cos_f32 v58, v58
    v_fma_f32 v54, 2.0, v54, -1.0
    v_fma_f32 v57, 2.0, v57, -1.0
    v_lshl_or_b32 v50, v52, 16, v50
    v_cvt_pk_bf16_f32 v53, v53, v56
    v_cvt_pk_bf16_f32 v55, v55, v58
    ds_write_b32 v1, v50 offset:960
    v_cvt_pk_bf16_f32 v54, v54, v57
    ds_write_b32 v1, v53 offset:0
    ds_write_b32 v1, v55 offset:640
    ds_write_b32 v1, v54 offset:320
    s_cmp_gt_u32 s17, 128
    s_cbranch_scc1 k2_pre2_51
k2_pre_end51:
    s_sub_u32 s42, s42, 128
    v_cmp_gt_i32 vcc, s42, v4
    v_lshl_add_u32 v19, v19, 5, v5
    s_mov_b64 exec, vcc
    buffer_load_dwordx4 v[44:47], v19, s[4:7], 0 offen
    s_mov_b64 exec, -1
    ds_read_u16 v19, v4 offset:27904
    ds_read_b128 v[48:51], v2 offset:960
    ds_read_b128 v[52:55], v2 offset:0
    ds_read_b128 v[56:59], v2 offset:320
    s_waitcnt vmcnt(4)
    ds_read_u16 v16, v6 offset:128
    s_mov_b32 s40, 0xc1200000
    s_mov_b32 s41, 0x3fb8aa3b
    s_waitcnt lgkmcnt(0)
    v_lshlrev_b32 v16, 16, v16
    v_sub_f32 v8, v16, v12
    v_sub_f32 v9, v16, v13
    v_sub_f32 v10, v16, v14
    v_sub_f32 v11, v16, v15
    v_cvt_pk_bf16_f32 v8, 0, v8
    v_cvt_pk_bf16_f32 v9, 0, v9
    v_cvt_pk_bf16_f32 v10, 0, v10
    v_cvt_pk_bf16_f32 v11, 0, v11
    v_mul_f32 v8, v8, v8
    v_mul_f32 v9, v9, v9
    v_mul_f32 v10, v10, v10
    v_mul_f32 v11, v11, v11
    v_cvt_pk_bf16_f32 v8, 0, v8
    v_cvt_pk_bf16_f32 v9, 0, v9
    v_cvt_pk_bf16_f32 v10, 0, v10
    v_cvt_pk_bf16_f32 v11, 0, v11
    v_mul_f32 v8, s40, v8
    v_mul_f32 v9, s40, v9
    v_mul_f32 v10, s40, v10
    v_mul_f32 v11, s40, v11
    v_cvt_pk_bf16_f32 v8, 0, v8
    v_cvt_pk_bf16_f32 v9, 0, v9
    v_cvt_pk_bf16_f32 v10, 0, v10
    v_cvt_pk_bf16_f32 v11, 0, v11
    v_mul_f32 v8, s41, v8
    v_mul_f32 v9, s41, v9
    v_mul_f32 v10, s41, v10
    v_mul_f32 v11, s41, v11
    v_exp_f32 v8, v8
    v_exp_f32 v9, v9
    v_exp_f32 v10, v10
    v_exp_f32 v11, v11
    s_nop 0
    v_cvt_pk_bf16_f32 v16, v8, v9
    v_cvt_pk_bf16_f32 v17, v10, v11
    ds_write_b64 v7, v[16:17] offset:2048
    s_add_u32 s60, s60, 1
    s_and_b32 s60, s60, 3
    s_cmp_lt_u32 s60, 2
    s_cbranch_scc1 k2_pr01_52
    s_cmp_eq_u32 s60, 2
    s_cbranch_scc1 k2_pr2_52
    s_setprio 3
    s_branch k2_prd_52
k2_pr2_52:
    s_setprio 2
    s_branch k2_prd_52
k2_pr01_52:
    s_cmp_eq_u32 s60, 0
    s_cbranch_scc1 k2_pr0_52
    s_setprio 1
    s_branch k2_prd_52
k2_pr0_52:
    s_setprio 0
k2_prd_52:
    s_cmp_le_u32 s17, 0
    s_cbranch_scc1 k2_skip53
    v_mfma_f32_16x16x32_bf16 v[60:63], v[28:31], v[20:23], 0
    v_mfma_f32_16x16x32_bf16 v[64:67], v[28:31], v[24:27], 0
    ds_read_b128 v[28:31], v2 offset:640
    s_waitcnt lgkmcnt(3)
    v_pk_lshlrev_b16 v48, v0, v48 op_sel_hi:[0,1]
    v_pk_lshlrev_b16 v49, v0, v49 op_sel_hi:[0,1]
    v_pk_lshlrev_b16 v50, v0, v50 op_sel_hi:[0,1]
    v_pk_lshlrev_b16 v51, v0, v51 op_sel_hi:[0,1]
    v_pk_ashrrev_i16 v48, 15, v48 op_sel_hi:[0,1]
    v_pk_ashrrev_i16 v49, 15, v49 op_sel_hi:[0,1]
    v_pk_ashrrev_i16 v50, 15, v50 op_sel_hi:[0,1]
    v_pk_ashrrev_i16 v51, 15, v51 op_sel_hi:[0,1]
    s_nop 1
    v_cvt_pk_bf16_f32 v60, v60, v61
    v_cvt_pk_bf16_f32 v61, v62, v63
    v_cvt_pk_bf16_f32 v62, v64, v65
    v_cvt_pk_bf16_f32 v63, v66, v67
    s_waitcnt lgkmcnt(1)
    v_and_b32 v52, v48, v52
    v_and_b32 v53, v49, v53
    v_and_b32 v54, v50, v54
    v_and_b32 v55, v51, v55
    v_and_b32 v56, v48, v56
    v_and_b32 v57, v49, v57
    v_and_b32 v58, v50, v58
    v_and_b32 v59, v51, v59
    v_mfma_f32_16x16x32_bf16 v[80:83], v[60:63], v[52:55], v[80:83]
    s_waitcnt lgkmcnt(0)
    v_and_b32 v28, v48, v28
    v_mfma_f32_16x16x32_bf16 v[84:87], v[60:63], v[56:59], v[84:87]
    v_and_b32 v29, v49, v29
    v_and_b32 v30, v50, v30
    v_and_b32 v31, v51, v31
    s_nop 1
    v_mfma_f32_16x16x32_bf16 v[88:91], v[60:63], v[28:31], v[88:91]
k2_skip53:
    s_waitcnt lgkmcnt(3)
    s_lshl2_add_u32 s42, s18, s31
    v_cmp_gt_i32 vcc, s42, v4
    v_lshl_add_u32 v19, v19, 5, v5
    s_mov_b64 exec, vcc
    buffer_load_dwordx4 v[28:31], v19, s[4:7], 0 offen
    s_mov_b64 exec, -1
    ds_read_u16 v19, v4 offset:28032
    ds_read_b128 v[48:51], v2 offset:1024
    ds_read_b128 v[52:55], v2 offset:64
    ds_read_b128 v[56:59], v2 offset:384
    s_waitcnt vmcnt(4)
    s_cmp_le_u32 s17, 32
    s_cbranch_scc1 k2_skip54
    v_mfma_f32_16x16x32_bf16 v[60:63], v[32:35], v[20:23], 0
    v_mfma_f32_16x16x32_bf16 v[64:67], v[32:35], v[24:27], 0
    ds_read_b128 v[32:35], v2 offset:704
    s_waitcnt lgkmcnt(3)
    v_pk_lshlrev_b16 v48, v0, v48 op_sel_hi:[0,1]
    v_pk_lshlrev_b16 v49, v0, v49 op_sel_hi:[0,1]
    v_pk_lshlrev_b16 v50, v0, v50 op_sel_hi:[0,1]
    v_pk_lshlrev_b16 v51, v0, v51 op_sel_hi:[0,1]
    v_pk_ashrrev_i16 v48, 15, v48 op_sel_hi:[0,1]
    v_pk_ashrrev_i16 v49, 15, v49 op_sel_hi:[0,1]
    v_pk_ashrrev_i16 v50, 15, v50 op_sel_hi:[0,1]
    v_pk_ashrrev_i16 v51, 15, v51 op_sel_hi:[0,1]
    s_nop 1
    v_cvt_pk_bf16_f32 v60, v60, v61
    v_cvt_pk_bf16_f32 v61, v62, v63
    v_cvt_pk_bf16_f32 v62, v64, v65
    v_cvt_pk_bf16_f32 v63, v66, v67
    s_waitcnt lgkmcnt(1)
    v_and_b32 v52, v48, v52
    v_and_b32 v53, v49, v53
    v_and_b32 v54, v50, v54
    v_and_b32 v55, v51, v55
    v_and_b32 v56, v48, v56
    v_and_b32 v57, v49, v57
    v_and_b32 v58, v50, v58
    v_and_b32 v59, v51, v59
    v_mfma_f32_16x16x32_bf16 v[80:83], v[60:63], v[52:55], v[80:83]
    s_waitcnt lgkmcnt(0)
    v_and_b32 v32, v48, v32
    v_mfma_f32_16x16x32_bf16 v[84:87], v[60:63], v[56:59], v[84:87]
    v_and_b32 v33, v49, v33
    v_and_b32 v34, v50, v34
    v_and_b32 v35, v51, v35
    s_nop 1
    v_mfma_f32_16x16x32_bf16 v[88:91], v[60:63], v[32:35], v[88:91]
k2_skip54:
    s_waitcnt lgkmcnt(3)
    s_sub_u32 s42, s42, 128
    v_cmp_gt_i32 vcc, s42, v4
    v_lshl_add_u32 v19, v19, 5, v5
    s_mov_b64 exec, vcc
    buffer_load_dwordx4 v[32:35], v19, s[4:7], 0 offen
    s_mov_b64 exec, -1
    ds_read_u16 v19, v4 offset:28160
    ds_read_b128 v[48:51], v2 offset:1088
    ds_read_b128 v[52:55], v2 offset:128
    ds_read_b128 v[56:59], v2 offset:448
    s_waitcnt vmcnt(4)
    s_add_u32 s60, s60, 1
    s_and_b32 s60, s60, 3
    s_cmp_lt_u32 s60, 2
    s_cbranch_scc1 k2_pr01_55
    s_cmp_eq_u32 s60, 2
    s_cbranch_scc1 k2_pr2_55
    s_setprio 3
    s_branch k2_prd_55
k2_pr2_55:
    s_setprio 2
    s_branch k2_prd_55
k2_pr01_55:
    s_cmp_eq_u32 s60, 0
    s_cbranch_scc1 k2_pr0_55
    s_setprio 1
    s_branch k2_prd_55
k2_pr0_55:
    s_setprio 0
k2_prd_55:
    s_cmp_le_u32 s17, 64
    s_cbranch_scc1 k2_skip56
    v_mfma_f32_16x16x32_bf16 v[60:63], v[36:39], v[20:23], 0
    v_mfma_f32_16x16x32_bf16 v[64:67], v[36:39], v[24:27], 0
    ds_read_b128 v[36:39], v2 offset:768
    s_waitcnt lgkmcnt(3)
    v_pk_lshlrev_b16 v48, v0, v48 op_sel_hi:[0,1]
    v_pk_lshlrev_b16 v49, v0, v49 op_sel_hi:[0,1]
    v_pk_lshlrev_b16 v50, v0, v50 op_sel_hi:[0,1]
    v_pk_lshlrev_b16 v51, v0, v51 op_sel_hi:[0,1]
    v_pk_ashrrev_i16 v48, 15, v48 op_sel_hi:[0,1]
    v_pk_ashrrev_i16 v49, 15, v49 op_sel_hi:[0,1]
    v_pk_ashrrev_i16 v50, 15, v50 op_sel_hi:[0,1]
    v_pk_ashrrev_i16 v51, 15, v51 op_sel_hi:[0,1]
    s_nop 1
    v_cvt_pk_bf16_f32 v60, v60, v61
    v_cvt_pk_bf16_f32 v61, v62, v63
    v_cvt_pk_bf16_f32 v62, v64, v65
    v_cvt_pk_bf16_f32 v63, v66, v67
    s_waitcnt lgkmcnt(1)
    v_and_b32 v52, v48, v52
    v_and_b32 v53, v49, v53
    v_and_b32 v54, v50, v54
    v_and_b32 v55, v51, v55
    v_and_b32 v56, v48, v56
    v_and_b32 v57, v49, v57
    v_and_b32 v58, v50, v58
    v_and_b32 v59, v51, v59
    v_mfma_f32_16x16x32_bf16 v[80:83], v[60:63], v[52:55], v[80:83]
    s_waitcnt lgkmcnt(0)
    v_and_b32 v36, v48, v36
    v_mfma_f32_16x16x32_bf16 v[84:87], v[60:63], v[56:59], v[84:87]
    v_and_b32 v37, v49, v37
    v_and_b32 v38, v50, v38
    v_and_b32 v39, v51, v39
    s_nop 1
    v_mfma_f32_16x16x32_bf16 v[88:91], v[60:63], v[36:39], v[88:91]
k2_skip56:
    s_waitcnt lgkmcnt(3)
    s_sub_u32 s42, s42, 128
    v_cmp_gt_i32 vcc, s42, v4
    v_lshl_add_u32 v19, v19, 5, v5
    s_mov_b64 exec, vcc
    buffer_load_dwordx4 v[36:39], v19, s[4:7], 0 offen
    s_mov_b64 exec, -1
    ds_read_u16 v19, v4 offset:28288
    ds_read_b128 v[48:51], v2 offset:1152
    ds_read_b128 v[52:55], v2 offset:192
    ds_read_b128 v[56:59], v2 offset:512
    s_waitcnt vmcnt(4)
    s_cmp_le_u32 s17, 96
    s_cbranch_scc1 k2_skip57
    v_mfma_f32_16x16x32_bf16 v[60:63], v[40:43], v[20:23], 0
    v_mfma_f32_16x16x32_bf16 v[64:67], v[40:43], v[24:27], 0
    ds_read_b128 v[40:43], v2 offset:832
    s_waitcnt lgkmcnt(3)
    v_pk_lshlrev_b16 v48, v0, v48 op_sel_hi:[0,1]
    v_pk_lshlrev_b16 v49, v0, v49 op_sel_hi:[0,1]
    v_pk_lshlrev_b16 v50, v0, v50 op_sel_hi:[0,1]
    v_pk_lshlrev_b16 v51, v0, v51 op_sel_hi:[0,1]
    v_pk_ashrrev_i16 v48, 15, v48 op_sel_hi:[0,1]
    v_pk_ashrrev_i16 v49, 15, v49 op_sel_hi:[0,1]
    v_pk_ashrrev_i16 v50, 15, v50 op_sel_hi:[0,1]
    v_pk_ashrrev_i16 v51, 15, v51 op_sel_hi:[0,1]
    s_nop 1
    v_cvt_pk_bf16_f32 v60, v60, v61
    v_cvt_pk_bf16_f32 v61, v62, v63
    v_cvt_pk_bf16_f32 v62, v64, v65
    v_cvt_pk_bf16_f32 v63, v66, v67
    s_waitcnt lgkmcnt(1)
    v_and_b32 v52, v48, v52
    v_and_b32 v53, v49, v53
    v_and_b32 v54, v50, v54
    v_and_b32 v55, v51, v55
    v_and_b32 v56, v48, v56
    v_and_b32 v57, v49, v57
    v_and_b32 v58, v50, v58
    v_and_b32 v59, v51, v59
    v_mfma_f32_16x16x32_bf16 v[80:83], v[60:63], v[52:55], v[80:83]
    s_waitcnt lgkmcnt(0)
    v_and_b32 v40, v48, v40
    v_mfma_f32_16x16x32_bf16 v[84:87], v[60:63], v[56:59], v[84:87]
    v_and_b32 v41, v49, v41
    v_and_b32 v42, v50, v42
    v_and_b32 v43, v51, v43
    s_nop 1
    v_mfma_f32_16x16x32_bf16 v[88:91], v[60:63], v[40:43], v[88:91]
k2_skip57:
    s_waitcnt lgkmcnt(3)
    s_sub_u32 s42, s42, 128
    v_cmp_gt_i32 vcc, s42, v4
    v_lshl_add_u32 v19, v19, 5, v5
    s_mov_b64 exec, vcc
    buffer_load_dwordx4 v[40:43], v19, s[4:7], 0 offen
    s_mov_b64 exec, -1
    ds_read_u16 v19, v4 offset:28416
    v_lshlrev_b32 v51, 2, v3
    ds_read_b64 v[48:49], v51 offset:27904
    ds_read_u16 v50, v3 offset:1344
    s_waitcnt vmcnt(4)
    s_cmp_gt_u32 s17, 128
    s_cbranch_scc1 k2_rare58
k2_rareb58:
    s_waitcnt lgkmcnt(0)
    s_cmp_eq_u32 s18, 0
    s_cbranch_scc1 k2_pre_end59
    v_mov_b32 v51, 0x1010
    v_lshrrev_b32 v52, 8, v50
    v_and_b32 v48, 0xffff0000, v48
    v_and_b32 v49, 0xffff0000, v49
    ds_write_b16 v3, v51 offset:1344
    v_lshrrev_b32 v50, v50, s43
    v_lshrrev_b32 v52, v52, s43
    v_mul_f32 v53, 0.15915494, v48
    v_mul_f32 v55, 0x40400000, v48
    v_mul_f32 v56, 0.15915494, v49
    v_mul_f32 v58, 0x40400000, v49
    v_fract_f32 v53, v53
    v_cvt_pk_bf16_f32 v55, 0, v55
    v_fract_f32 v56, v56
    v_cvt_pk_bf16_f32 v58, 0, v58
    v_cos_f32 v53, v53
    v_mul_f32 v55, 0.15915494, v55
    v_cos_f32 v56, v56
    v_mul_f32 v58, 0.15915494, v58
    v_fract_f32 v55, v55
    v_fract_f32 v58, v58
    v_mul_f32 v54, v53, v53
    v_mul_f32 v57, v56, v56
    v_cos_f32 v55, v55
    v_cos_f32 v58, v58
    v_fma_f32 v54, 2.0, v54, -1.0
    v_fma_f32 v57, 2.0, v57, -1.0
    v_lshl_or_b32 v50, v52, 16, v50
    v_cvt_pk_bf16_f32 v53, v53, v56
    v_cvt_pk_bf16_f32 v55, v55, v58
    ds_write_b32 v1, v50 offset:960
    v_cvt_pk_bf16_f32 v54, v54, v57
    ds_write_b32 v1, v53 offset:0
    ds_write_b32 v1, v55 offset:640
    ds_write_b32 v1, v54 offset:320
    s_cmp_gt_u32 s18, 128
    s_cbranch_scc1 k2_pre2_59
k2_pre_end59:
    s_sub_u32 s42, s42, 128
    v_cmp_gt_i32 vcc, s42, v4
    v_lshl_add_u32 v19, v19, 5, v5
    s_mov_b64 exec, vcc
    buffer_load_dwordx4 v[44:47], v19, s[4:7], 0 offen
    s_mov_b64 exec, -1
    ds_read_u16 v19, v4 offset:28544
    ds_read_b128 v[48:51], v2 offset:960
    ds_read_b128 v[52:55], v2 offset:0
    ds_read_b128 v[56:59], v2 offset:320
    s_waitcnt vmcnt(4)
    s_load_dwordx2 s[64:65], s[0:1], 88
    s_cmp_eq_u32 s37, 0
    s_cbranch_scc1 k2_nf60
    v_mov_b32 v6, 640
    v_mov_b32 v18, 1
    ds_write_b32 v6, v18
k2_nf60:
    s_waitcnt lgkmcnt(0)
    s_barrier
    s_add_u32 s60, s60, 1
    s_and_b32 s60, s60, 3
    s_cmp_lt_u32 s60, 2
    s_cbranch_scc1 k2_pr01_61
    s_cmp_eq_u32 s60, 2
    s_cbranch_scc1 k2_pr2_61
    s_setprio 3
    s_branch k2_prd_61
k2_pr2_61:
    s_setprio 2
    s_branch k2_prd_61
k2_pr01_61:
    s_cmp_eq_u32 s60, 0
    s_cbranch_scc1 k2_pr0_61
    s_setprio 1
    s_branch k2_prd_61
k2_pr0_61:
    s_setprio 0
k2_prd_61:
    s_cmp_le_u32 s18, 0
    s_cbranch_scc1 k2_skip62
    v_mfma_f32_16x16x32_bf16 v[60:63], v[28:31], v[20:23], 0
    v_mfma_f32_16x16x32_bf16 v[64:67], v[28:31], v[24:27], 0
    ds_read_b128 v[28:31], v2 offset:640
    s_waitcnt lgkmcnt(3)
    v_pk_lshlrev_b16 v48, v0, v48 op_sel_hi:[0,1]
    v_pk_lshlrev_b16 v49, v0, v49 op_sel_hi:[0,1]
    v_pk_lshlrev_b16 v50, v0, v50 op_sel_hi:[0,1]
    v_pk_lshlrev_b16 v51, v0, v51 op_sel_hi:[0,1]
    v_pk_ashrrev_i16 v48, 15, v48 op_sel_hi:[0,1]
    v_pk_ashrrev_i16 v49, 15, v49 op_sel_hi:[0,1]
    v_pk_ashrrev_i16 v50, 15, v50 op_sel_hi:[0,1]
    v_pk_ashrrev_i16 v51, 15, v51 op_sel_hi:[0,1]
    s_nop 1
    v_cvt_pk_bf16_f32 v60, v60, v61
    v_cvt_pk_bf16_f32 v61, v62, v63
    v_cvt_pk_bf16_f32 v62, v64, v65
    v_cvt_pk_bf16_f32 v63, v66, v67
    s_waitcnt lgkmcnt(1)
    v_and_b32 v52, v48, v52
    v_and_b32 v53, v49, v53
    v_and_b32 v54, v50, v54
    v_and_b32 v55, v51, v55
    v_and_b32 v56, v48, v56
    v_and_b32 v57, v49, v57
    v_and_b32 v58, v50, v58
    v_and_b32 v59, v51, v59
    v_mfma_f32_16x16x32_bf16 v[92:95], v[60:63], v[52:55], v[92:95]
    s_waitcnt lgkmcnt(0)
    v_and_b32 v28, v48, v28
    v_mfma_f32_16x16x32_bf16 v[96:99], v[60:63], v[56:59], v[96:99]
    v_and_b32 v29, v49, v29
    v_and_b32 v30, v50, v30
    v_and_b32 v31, v51, v31
    s_nop 1
    v_mfma_f32_16x16x32_bf16 v[100:103], v[60:63], v[28:31], v[100:103]
k2_skip62:
    s_waitcnt lgkmcnt(3)
    s_lshl2_add_u32 s42, s19, s31
    v_cmp_gt_i32 vcc, s42, v4
    v_lshl_add_u32 v19, v19, 5, v5
    s_mov_b64 exec, vcc
    buffer_load_dwordx4 v[28:31], v19, s[4:7], 0 offen
    s_mov_b64 exec, -1
    ds_read_u16 v19, v4 offset:28672
    ds_read_b128 v[48:51], v2 offset:1024
    ds_read_b128 v[52:55], v2 offset:64
    ds_read_b128 v[56:59], v2 offset:384
    s_waitcnt vmcnt(4)
    s_cmp_le_u32 s18, 32
    s_cbranch_scc1 k2_skip63
    v_mfma_f32_16x16x32_bf16 v[60:63], v[32:35], v[20:23], 0
    v_mfma_f32_16x16x32_bf16 v[64:67], v[32:35], v[24:27], 0
    ds_read_b128 v[32:35], v2 offset:704
    s_waitcnt lgkmcnt(3)
    v_pk_lshlrev_b16 v48, v0, v48 op_sel_hi:[0,1]
    v_pk_lshlrev_b16 v49, v0, v49 op_sel_hi:[0,1]
    v_pk_lshlrev_b16 v50, v0, v50 op_sel_hi:[0,1]
    v_pk_lshlrev_b16 v51, v0, v51 op_sel_hi:[0,1]
    v_pk_ashrrev_i16 v48, 15, v48 op_sel_hi:[0,1]
    v_pk_ashrrev_i16 v49, 15, v49 op_sel_hi:[0,1]
    v_pk_ashrrev_i16 v50, 15, v50 op_sel_hi:[0,1]
    v_pk_ashrrev_i16 v51, 15, v51 op_sel_hi:[0,1]
    s_nop 1
    v_cvt_pk_bf16_f32 v60, v60, v61
    v_cvt_pk_bf16_f32 v61, v62, v63
    v_cvt_pk_bf16_f32 v62, v64, v65
    v_cvt_pk_bf16_f32 v63, v66, v67
    s_waitcnt lgkmcnt(1)
    v_and_b32 v52, v48, v52
    v_and_b32 v53, v49, v53
    v_and_b32 v54, v50, v54
    v_and_b32 v55, v51, v55
    v_and_b32 v56, v48, v56
    v_and_b32 v57, v49, v57
    v_and_b32 v58, v50, v58
    v_and_b32 v59, v51, v59
    v_mfma_f32_16x16x32_bf16 v[92:95], v[60:63], v[52:55], v[92:95]
    s_waitcnt lgkmcnt(0)
    v_and_b32 v32, v48, v32
    v_mfma_f32_16x16x32_bf16 v[96:99], v[60:63], v[56:59], v[96:99]
    v_and_b32 v33, v49, v33
    v_and_b32 v34, v50, v34
    v_and_b32 v35, v51, v35
    s_nop 1
    v_mfma_f32_16x16x32_bf16 v[100:103], v[60:63], v[32:35], v[100:103]
k2_skip63:
    s_waitcnt lgkmcnt(3)
    s_sub_u32 s42, s42, 128
    v_cmp_gt_i32 vcc, s42, v4
    v_lshl_add_u32 v19, v19, 5, v5
    s_mov_b64 exec, vcc
    buffer_load_dwordx4 v[32:35], v19, s[4:7], 0 offen
    s_mov_b64 exec, -1
    ds_read_u16 v19, v4 offset:28800
    ds_read_b128 v[48:51], v2 offset:1088
    ds_read_b128 v[52:55], v2 offset:128
    ds_read_b128 v[56:59], v2 offset:448
    s_waitcnt vmcnt(4)
    s_add_u32 s60, s60, 1
    s_and_b32 s60, s60, 3
    s_cmp_lt_u32 s60, 2
    s_cbranch_scc1 k2_pr01_64
    s_cmp_eq_u32 s60, 2
    s_cbranch_scc1 k2_pr2_64
    s_setprio 3
    s_branch k2_prd_64
k2_pr2_64:
    s_setprio 2
    s_branch k2_prd_64
k2_pr01_64:
    s_cmp_eq_u32 s60, 0
    s_cbranch_scc1 k2_pr0_64
    s_setprio 1
    s_branch k2_prd_64
k2_pr0_64:
    s_setprio 0
k2_prd_64:
    s_cmp_le_u32 s18, 64
    s_cbranch_scc1 k2_skip65
    v_mfma_f32_16x16x32_bf16 v[60:63], v[36:39], v[20:23], 0
    v_mfma_f32_16x16x32_bf16 v[64:67], v[36:39], v[24:27], 0
    ds_read_b128 v[36:39], v2 offset:768
    s_waitcnt lgkmcnt(3)
    v_pk_lshlrev_b16 v48, v0, v48 op_sel_hi:[0,1]
    v_pk_lshlrev_b16 v49, v0, v49 op_sel_hi:[0,1]
    v_pk_lshlrev_b16 v50, v0, v50 op_sel_hi:[0,1]
    v_pk_lshlrev_b16 v51, v0, v51 op_sel_hi:[0,1]
    v_pk_ashrrev_i16 v48, 15, v48 op_sel_hi:[0,1]
    v_pk_ashrrev_i16 v49, 15, v49 op_sel_hi:[0,1]
    v_pk_ashrrev_i16 v50, 15, v50 op_sel_hi:[0,1]
    v_pk_ashrrev_i16 v51, 15, v51 op_sel_hi:[0,1]
    s_nop 1
    v_cvt_pk_bf16_f32 v60, v60, v61
    v_cvt_pk_bf16_f32 v61, v62, v63
    v_cvt_pk_bf16_f32 v62, v64, v65
    v_cvt_pk_bf16_f32 v63, v66, v67
    s_waitcnt lgkmcnt(1)
    v_and_b32 v52, v48, v52
    v_and_b32 v53, v49, v53
    v_and_b32 v54, v50, v54
    v_and_b32 v55, v51, v55
    v_and_b32 v56, v48, v56
    v_and_b32 v57, v49, v57
    v_and_b32 v58, v50, v58
    v_and_b32 v59, v51, v59
    v_mfma_f32_16x16x32_bf16 v[92:95], v[60:63], v[52:55], v[92:95]
    s_waitcnt lgkmcnt(0)
    v_and_b32 v36, v48, v36
    v_mfma_f32_16x16x32_bf16 v[96:99], v[60:63], v[56:59], v[96:99]
    v_and_b32 v37, v49, v37
    v_and_b32 v38, v50, v38
    v_and_b32 v39, v51, v39
    s_nop 1
    v_mfma_f32_16x16x32_bf16 v[100:103], v[60:63], v[36:39], v[100:103]
k2_skip65:
    s_waitcnt lgkmcnt(3)
    s_sub_u32 s42, s42, 128
    v_cmp_gt_i32 vcc, s42, v4
    v_lshl_add_u32 v19, v19, 5, v5
    s_mov_b64 exec, vcc
    buffer_load_dwordx4 v[36:39], v19, s[4:7], 0 offen
    s_mov_b64 exec, -1
    ds_read_u16 v19, v4 offset:28928
    ds_read_b128 v[48:51], v2 offset:1152
    ds_read_b128 v[52:55], v2 offset:192
    ds_read_b128 v[56:59], v2 offset:512
    s_waitcnt vmcnt(4)
    s_cmp_le_u32 s18, 96
    s_cbranch_scc1 k2_skip66
    v_mfma_f32_16x16x32_bf16 v[60:63], v[40:43], v[20:23], 0
    v_mfma_f32_16x16x32_bf16 v[64:67], v[40:43], v[24:27], 0
    ds_read_b128 v[40:43], v2 offset:832
    s_waitcnt lgkmcnt(3)
    v_pk_lshlrev_b16 v48, v0, v48 op_sel_hi:[0,1]
    v_pk_lshlrev_b16 v49, v0, v49 op_sel_hi:[0,1]
    v_pk_lshlrev_b16 v50, v0, v50 op_sel_hi:[0,1]
    v_pk_lshlrev_b16 v51, v0, v51 op_sel_hi:[0,1]
    v_pk_ashrrev_i16 v48, 15, v48 op_sel_hi:[0,1]
    v_pk_ashrrev_i16 v49, 15, v49 op_sel_hi:[0,1]
    v_pk_ashrrev_i16 v50, 15, v50 op_sel_hi:[0,1]
    v_pk_ashrrev_i16 v51, 15, v51 op_sel_hi:[0,1]
    s_nop 1
    v_cvt_pk_bf16_f32 v60, v60, v61
    v_cvt_pk_bf16_f32 v61, v62, v63
    v_cvt_pk_bf16_f32 v62, v64, v65
    v_cvt_pk_bf16_f32 v63, v66, v67
    s_waitcnt lgkmcnt(1)
    v_and_b32 v52, v48, v52
    v_and_b32 v53, v49, v53
    v_and_b32 v54, v50, v54
    v_and_b32 v55, v51, v55
    v_and_b32 v56, v48, v56
    v_and_b32 v57, v49, v57
    v_and_b32 v58, v50, v58
    v_and_b32 v59, v51, v59
    v_mfma_f32_16x16x32_bf16 v[92:95], v[60:63], v[52:55], v[92:95]
    s_waitcnt lgkmcnt(0)
    v_and_b32 v40, v48, v40
    v_mfma_f32_16x16x32_bf16 v[96:99], v[60:63], v[56:59], v[96:99]
    v_and_b32 v41, v49, v41
    v_and_b32 v42, v50, v42
    v_and_b32 v43, v51, v43
    s_nop 1
    v_mfma_f32_16x16x32_bf16 v[100:103], v[60:63], v[40:43], v[100:103]
k2_skip66:
    s_waitcnt lgkmcnt(3)
    s_sub_u32 s42, s42, 128
    v_cmp_gt_i32 vcc, s42, v4
    v_lshl_add_u32 v19, v19, 5, v5
    s_mov_b64 exec, vcc
    buffer_load_dwordx4 v[40:43], v19, s[4:7], 0 offen
    s_mov_b64 exec, -1
    ds_read_u16 v19, v4 offset:29056
    v_lshlrev_b32 v51, 2, v3
    ds_read_b64 v[48:49], v51 offset:28544
    ds_read_u16 v50, v3 offset:1504
    s_waitcnt vmcnt(4)
    s_cmp_gt_u32 s18, 128
    s_cbranch_scc1 k2_rare67
k2_rareb67:
    s_waitcnt lgkmcnt(0)
    s_cmp_eq_u32 s19, 0
    s_cbranch_scc1 k2_pre_end68
    v_mov_b32 v51, 0x1010
    v_lshrrev_b32 v52, 8, v50
    v_and_b32 v48, 0xffff0000, v48
    v_and_b32 v49, 0xffff0000, v49
    ds_write_b16 v3, v51 offset:1504
    v_lshrrev_b32 v50, v50, s43
    v_lshrrev_b32 v52, v52, s43
    v_mul_f32 v53, 0.15915494, v48
    v_mul_f32 v55, 0x40400000, v48
    v_mul_f32 v56, 0.15915494, v49
    v_mul_f32 v58, 0x40400000, v49
    v_fract_f32 v53, v53
    v_cvt_pk_bf16_f32 v55, 0, v55
    v_fract_f32 v56, v56
    v_cvt_pk_bf16_f32 v58, 0, v58
    v_cos_f32 v53, v53
    v_mul_f32 v55, 0.15915494, v55
    v_cos_f32 v56, v56
    v_mul_f32 v58, 0.15915494, v58
    v_fract_f32 v55, v55
    v_fract_f32 v58, v58
    v_mul_f32 v54, v53, v53
    v_mul_f32 v57, v56, v56
    v_cos_f32 v55, v55
    v_cos_f32 v58, v58
    v_fma_f32 v54, 2.0, v54, -1.0
    v_fma_f32 v57, 2.0, v57, -1.0
    v_lshl_or_b32 v50, v52, 16, v50
    v_cvt_pk_bf16_f32 v53, v53, v56
    v_cvt_pk_bf16_f32 v55, v55, v58
    ds_write_b32 v1, v50 offset:960
    v_cvt_pk_bf16_f32 v54, v54, v57
    ds_write_b32 v1, v53 offset:0
    ds_write_b32 v1, v55 offset:640
    ds_write_b32 v1, v54 offset:320
    s_cmp_gt_u32 s19, 128
    s_cbranch_scc1 k2_pre2_68
k2_pre_end68:
    s_sub_u32 s42, s42, 128
    v_cmp_gt_i32 vcc, s42, v4
    v_lshl_add_u32 v19, v19, 5, v5
    s_mov_b64 exec, vcc
    buffer_load_dwordx4 v[44:47], v19, s[4:7], 0 offen
    s_mov_b64 exec, -1
    ds_read_u16 v19, v4 offset:29184
    ds_read_b128 v[48:51], v2 offset:960
    ds_read_b128 v[52:55], v2 offset:0
    ds_read_b128 v[56:59], v2 offset:320
    s_sub_u32 s41, s52, 8388608
    s_subb_u32 s38, s53, 0
    v_and_b32 v6, 15, v0
    v_lshrrev_b32 v7, 4, v0
    s_mul_i32 s39, s35, 80
    s_mul_i32 s40, s36, 1280
    s_add_u32 s39, s39, s40
    v_add_u32 v6, s39, v6
    v_lshlrev_b32 v6, 5, v6
    v_lshl_add_u32 v7, v7, 3, v6
    s_mov_b32 s80, s41
    s_mov_b32 s81, s38
    s_mov_b32 s82, 10240000
    s_mov_b32 s83, 0x00020000
    buffer_load_dwordx2 v[8:9], v7, s[80:83], 0 offen offset:0
    buffer_load_dwordx2 v[10:11], v7, s[80:83], 0 offen offset:512
    buffer_load_dwordx2 v[12:13], v7, s[80:83], 0 offen offset:1024
    buffer_load_dwordx2 v[14:15], v7, s[80:83], 0 offen offset:1536
    buffer_load_dwordx2 v[16:17], v7, s[80:83], 0 offen offset:2048
    s_waitcnt vmcnt(9)
    s_add_u32 s60, s60, 1
    s_and_b32 s60, s60, 3
    s_cmp_lt_u32 s60, 2
    s_cbranch_scc1 k2_pr01_69
    s_cmp_eq_u32 s60, 2
    s_cbranch_scc1 k2_pr2_69
    s_setprio 3
    s_branch k2_prd_69
k2_pr2_69:
    s_setprio 2
    s_branch k2_prd_69
k2_pr01_69:
    s_cmp_eq_u32 s60, 0
    s_cbranch_scc1 k2_pr0_69
    s_setprio 1
    s_branch k2_prd_69
k2_pr0_69:
    s_setprio 0
k2_prd_69:
    s_cmp_le_u32 s19, 0
    s_cbranch_scc1 k2_skip70
    v_mfma_f32_16x16x32_bf16 v[60:63], v[28:31], v[20:23], 0
    v_mfma_f32_16x16x32_bf16 v[64:67], v[28:31], v[24:27], 0
    ds_read_b128 v[28:31], v2 offset:640
    s_waitcnt lgkmcnt(3)
    v_pk_lshlrev_b16 v48, v0, v48 op_sel_hi:[0,1]
    v_pk_lshlrev_b16 v49, v0, v49 op_sel_hi:[0,1]
    v_pk_lshlrev_b16 v50, v0, v50 op_sel_hi:[0,1]
    v_pk_lshlrev_b16 v51, v0, v51 op_sel_hi:[0,1]
    v_pk_ashrrev_i16 v48, 15, v48 op_sel_hi:[0,1]
    v_pk_ashrrev_i16 v49, 15, v49 op_sel_hi:[0,1]
    v_pk_ashrrev_i16 v50, 15, v50 op_sel_hi:[0,1]
    v_pk_ashrrev_i16 v51, 15, v51 op_sel_hi:[0,1]
    s_nop 1
    v_cvt_pk_bf16_f32 v60, v60, v61
    v_cvt_pk_bf16_f32 v61, v62, v63
    v_cvt_pk_bf16_f32 v62, v64, v65
    v_cvt_pk_bf16_f32 v63, v66, v67
    s_waitcnt lgkmcnt(1)
    v_and_b32 v52, v48, v52
    v_and_b32 v53, v49, v53
    v_and_b32 v54, v50, v54
    v_and_b32 v55, v51, v55
    v_and_b32 v56, v48, v56
    v_and_b32 v57, v49, v57
    v_and_b32 v58, v50, v58
    v_and_b32 v59, v51, v59
    v_mfma_f32_16x16x32_bf16 v[104:107], v[60:63], v[52:55], v[104:107]
    s_waitcnt lgkmcnt(0)
    v_and_b32 v28, v48, v28
    v_mfma_f32_16x16x32_bf16 v[108:111], v[60:63], v[56:59], v[108:111]
    v_and_b32 v29, v49, v29
    v_and_b32 v30, v50, v30
    v_and_b32 v31, v51, v31
    s_nop 1
    v_mfma_f32_16x16x32_bf16 v[112:115], v[60:63], v[28:31], v[112:115]
k2_skip70:
    s_waitcnt lgkmcnt(3)
    s_lshl2_add_u32 s42, s20, s31
    v_cmp_gt_i32 vcc, s42, v4
    v_lshl_add_u32 v19, v19, 5, v5
    s_mov_b64 exec, vcc
    buffer_load_dwordx4 v[28:31], v19, s[4:7], 0 offen
    s_mov_b64 exec, -1
    ds_read_u16 v19, v4 offset:29312
    ds_read_b128 v[48:51], v2 offset:1024
    ds_read_b128 v[52:55], v2 offset:64
    ds_read_b128 v[56:59], v2 offset:384
    s_waitcnt vmcnt(9)
    s_cmp_le_u32 s19, 32
    s_cbranch_scc1 k2_skip71
    v_mfma_f32_16x16x32_bf16 v[60:63], v[32:35], v[20:23], 0
    v_mfma_f32_16x16x32_bf16 v[64:67], v[32:35], v[24:27], 0
    ds_read_b128 v[32:35], v2 offset:704
    s_waitcnt lgkmcnt(3)
    v_pk_lshlrev_b16 v48, v0, v48 op_sel_hi:[0,1]
    v_pk_lshlrev_b16 v49, v0, v49 op_sel_hi:[0,1]
    v_pk_lshlrev_b16 v50, v0, v50 op_sel_hi:[0,1]
    v_pk_lshlrev_b16 v51, v0, v51 op_sel_hi:[0,1]
    v_pk_ashrrev_i16 v48, 15, v48 op_sel_hi:[0,1]
    v_pk_ashrrev_i16 v49, 15, v49 op_sel_hi:[0,1]
    v_pk_ashrrev_i16 v50, 15, v50 op_sel_hi:[0,1]
    v_pk_ashrrev_i16 v51, 15, v51 op_sel_hi:[0,1]
    s_nop 1
    v_cvt_pk_bf16_f32 v60, v60, v61
    v_cvt_pk_bf16_f32 v61, v62, v63
    v_cvt_pk_bf16_f32 v62, v64, v65
    v_cvt_pk_bf16_f32 v63, v66, v67
    s_waitcnt lgkmcnt(1)
    v_and_b32 v52, v48, v52
    v_and_b32 v53, v49, v53
    v_and_b32 v54, v50, v54
    v_and_b32 v55, v51, v55
    v_and_b32 v56, v48, v56
    v_and_b32 v57, v49, v57
    v_and_b32 v58, v50, v58
    v_and_b32 v59, v51, v59
    v_mfma_f32_16x16x32_bf16 v[104:107], v[60:63], v[52:55], v[104:107]
    s_waitcnt lgkmcnt(0)
    v_and_b32 v32, v48, v32
    v_mfma_f32_16x16x32_bf16 v[108:111], v[60:63], v[56:59], v[108:111]
    v_and_b32 v33, v49, v33
    v_and_b32 v34, v50, v34
    v_and_b32 v35, v51, v35
    s_nop 1
    v_mfma_f32_16x16x32_bf16 v[112:115], v[60:63], v[32:35], v[112:115]
k2_skip71:
    s_waitcnt lgkmcnt(3)
    s_sub_u32 s42, s42, 128
    v_cmp_gt_i32 vcc, s42, v4
    v_lshl_add_u32 v19, v19, 5, v5
    s_mov_b64 exec, vcc
    buffer_load_dwordx4 v[32:35], v19, s[4:7], 0 offen
    s_mov_b64 exec, -1
    ds_read_u16 v19, v4 offset:29440
    ds_read_b128 v[48:51], v2 offset:1088
    ds_read_b128 v[52:55], v2 offset:128
    ds_read_b128 v[56:59], v2 offset:448
    s_waitcnt vmcnt(9)
    s_add_u32 s60, s60, 1
    s_and_b32 s60, s60, 3
    s_cmp_lt_u32 s60, 2
    s_cbranch_scc1 k2_pr01_72
    s_cmp_eq_u32 s60, 2
    s_cbranch_scc1 k2_pr2_72
    s_setprio 3
    s_branch k2_prd_72
k2_pr2_72:
    s_setprio 2
    s_branch k2_prd_72
k2_pr01_72:
    s_cmp_eq_u32 s60, 0
    s_cbranch_scc1 k2_pr0_72
    s_setprio 1
    s_branch k2_prd_72
k2_pr0_72:
    s_setprio 0
k2_prd_72:
    s_cmp_le_u32 s19, 64
    s_cbranch_scc1 k2_skip73
    v_mfma_f32_16x16x32_bf16 v[60:63], v[36:39], v[20:23], 0
    v_mfma_f32_16x16x32_bf16 v[64:67], v[36:39], v[24:27], 0
    ds_read_b128 v[36:39], v2 offset:768
    s_waitcnt lgkmcnt(3)
    v_pk_lshlrev_b16 v48, v0, v48 op_sel_hi:[0,1]
    v_pk_lshlrev_b16 v49, v0, v49 op_sel_hi:[0,1]
    v_pk_lshlrev_b16 v50, v0, v50 op_sel_hi:[0,1]
    v_pk_lshlrev_b16 v51, v0, v51 op_sel_hi:[0,1]
    v_pk_ashrrev_i16 v48, 15, v48 op_sel_hi:[0,1]
    v_pk_ashrrev_i16 v49, 15, v49 op_sel_hi:[0,1]
    v_pk_ashrrev_i16 v50, 15, v50 op_sel_hi:[0,1]
    v_pk_ashrrev_i16 v51, 15, v51 op_sel_hi:[0,1]
    s_nop 1
    v_cvt_pk_bf16_f32 v60, v60, v61
    v_cvt_pk_bf16_f32 v61, v62, v63
    v_cvt_pk_bf16_f32 v62, v64, v65
    v_cvt_pk_bf16_f32 v63, v66, v67
    s_waitcnt lgkmcnt(1)
    v_and_b32 v52, v48, v52
    v_and_b32 v53, v49, v53
    v_and_b32 v54, v50, v54
    v_and_b32 v55, v51, v55
    v_and_b32 v56, v48, v56
    v_and_b32 v57, v49, v57
    v_and_b32 v58, v50, v58
    v_and_b32 v59, v51, v59
    v_mfma_f32_16x16x32_bf16 v[104:107], v[60:63], v[52:55], v[104:107]
    s_waitcnt lgkmcnt(0)
    v_and_b32 v36, v48, v36
    v_mfma_f32_16x16x32_bf16 v[108:111], v[60:63], v[56:59], v[108:111]
    v_and_b32 v37, v49, v37
    v_and_b32 v38, v50, v38
    v_and_b32 v39, v51, v39
    s_nop 1
    v_mfma_f32_16x16x32_bf16 v[112:115], v[60:63], v[36:39], v[112:115]
k2_skip73:
    s_waitcnt lgkmcnt(3)
    s_sub_u32 s42, s42, 128
    v_cmp_gt_i32 vcc, s42, v4
    v_lshl_add_u32 v19, v19, 5, v5
    s_mov_b64 exec, vcc
    buffer_load_dwordx4 v[36:39], v19, s[4:7], 0 offen
    s_mov_b64 exec, -1
    ds_read_u16 v19, v4 offset:29568
    ds_read_b128 v[48:51], v2 offset:1152
    ds_read_b128 v[52:55], v2 offset:192
    ds_read_b128 v[56:59], v2 offset:512
    s_waitcnt vmcnt(9)
    s_cmp_le_u32 s19, 96
    s_cbranch_scc1 k2_skip74
    v_mfma_f32_16x16x32_bf16 v[60:63], v[40:43], v[20:23], 0
    v_mfma_f32_16x16x32_bf16 v[64:67], v[40:43], v[24:27], 0
    ds_read_b128 v[40:43], v2 offset:832
    s_waitcnt lgkmcnt(3)
    v_pk_lshlrev_b16 v48, v0, v48 op_sel_hi:[0,1]
    v_pk_lshlrev_b16 v49, v0, v49 op_sel_hi:[0,1]
    v_pk_lshlrev_b16 v50, v0, v50 op_sel_hi:[0,1]
    v_pk_lshlrev_b16 v51, v0, v51 op_sel_hi:[0,1]
    v_pk_ashrrev_i16 v48, 15, v48 op_sel_hi:[0,1]
    v_pk_ashrrev_i16 v49, 15, v49 op_sel_hi:[0,1]
    v_pk_ashrrev_i16 v50, 15, v50 op_sel_hi:[0,1]
    v_pk_ashrrev_i16 v51, 15, v51 op_sel_hi:[0,1]
    s_nop 1
    v_cvt_pk_bf16_f32 v60, v60, v61
    v_cvt_pk_bf16_f32 v61, v62, v63
    v_cvt_pk_bf16_f32 v62, v64, v65
    v_cvt_pk_bf16_f32 v63, v66, v67
    s_waitcnt lgkmcnt(1)
    v_and_b32 v52, v48, v52
    v_and_b32 v53, v49, v53
    v_and_b32 v54, v50, v54
    v_and_b32 v55, v51, v55
    v_and_b32 v56, v48, v56
    v_and_b32 v57, v49, v57
    v_and_b32 v58, v50, v58
    v_and_b32 v59, v51, v59
    v_mfma_f32_16x16x32_bf16 v[104:107], v[60:63], v[52:55], v[104:107]
    s_waitcnt lgkmcnt(0)
    v_and_b32 v40, v48, v40
    v_mfma_f32_16x16x32_bf16 v[108:111], v[60:63], v[56:59], v[108:111]
    v_and_b32 v41, v49, v41
    v_and_b32 v42, v50, v42
    v_and_b32 v43, v51, v43
    s_nop 1
    v_mfma_f32_16x16x32_bf16 v[112:115], v[60:63], v[40:43], v[112:115]
k2_skip74:
    s_waitcnt lgkmcnt(3)
    s_sub_u32 s42, s42, 128
    v_cmp_gt_i32 vcc, s42, v4
    v_lshl_add_u32 v19, v19, 5, v5
    s_mov_b64 exec, vcc
    buffer_load_dwordx4 v[40:43], v19, s[4:7], 0 offen
    s_mov_b64 exec, -1
    ds_read_u16 v19, v4 offset:29696
    v_lshlrev_b32 v51, 2, v3
    ds_read_b64 v[48:49], v51 offset:29184
    ds_read_u16 v50, v3 offset:1664
    s_waitcnt vmcnt(4)
    s_cmp_gt_u32 s19, 128
    s_cbranch_scc1 k2_rare75
k2_rareb75:
    s_waitcnt lgkmcnt(0)
    s_cmp_eq_u32 s20, 0
    s_cbranch_scc1 k2_pre_end76
    v_mov_b32 v51, 0x1010
    v_lshrrev_b32 v52, 8, v50
    v_and_b32 v48, 0xffff0000, v48
    v_and_b32 v49, 0xffff0000, v49
    ds_write_b16 v3, v51 offset:1664
    v_lshrrev_b32 v50, v50, s43
    v_lshrrev_b32 v52, v52, s43
    v_mul_f32 v53, 0.15915494, v48
    v_mul_f32 v55, 0x40400000, v48
    v_mul_f32 v56, 0.15915494, v49
    v_mul_f32 v58, 0x40400000, v49
    v_fract_f32 v53, v53
    v_cvt_pk_bf16_f32 v55, 0, v55
    v_fract_f32 v56, v56
    v_cvt_pk_bf16_f32 v58, 0, v58
    v_cos_f32 v53, v53
    v_mul_f32 v55, 0.15915494, v55
    v_cos_f32 v56, v56
    v_mul_f32 v58, 0.15915494, v58
    v_fract_f32 v55, v55
    v_fract_f32 v58, v58
    v_mul_f32 v54, v53, v53
    v_mul_f32 v57, v56, v56
    v_cos_f32 v55, v55
    v_cos_f32 v58, v58
    v_fma_f32 v54, 2.0, v54, -1.0
    v_fma_f32 v57, 2.0, v57, -1.0
    v_lshl_or_b32 v50, v52, 16, v50
    v_cvt_pk_bf16_f32 v53, v53, v56
    v_cvt_pk_bf16_f32 v55, v55, v58
    ds_write_b32 v1, v50 offset:960
    v_cvt_pk_bf16_f32 v54, v54, v57
    ds_write_b32 v1, v53 offset:0
    ds_write_b32 v1, v55 offset:640
    ds_write_b32 v1, v54 offset:320
    s_cmp_gt_u32 s20, 128
    s_cbranch_scc1 k2_pre2_76
k2_pre_end76:
    s_sub_u32 s42, s42, 128
    v_cmp_gt_i32 vcc, s42, v4
    v_lshl_add_u32 v19, v19, 5, v5
    s_mov_b64 exec, vcc
    buffer_load_dwordx4 v[44:47], v19, s[4:7], 0 offen
    s_mov_b64 exec, -1
    ds_read_b128 v[48:51], v2 offset:960
    ds_read_b128 v[52:55], v2 offset:0
    ds_read_b128 v[56:59], v2 offset:320
    s_waitcnt vmcnt(4)
    s_add_u32 s60, s60, 1
    s_and_b32 s60, s60, 3
    s_cmp_lt_u32 s60, 2
    s_cbranch_scc1 k2_pr01_77
    s_cmp_eq_u32 s60, 2
    s_cbranch_scc1 k2_pr2_77
    s_setprio 3
    s_branch k2_prd_77
k2_pr2_77:
    s_setprio 2
    s_branch k2_prd_77
k2_pr01_77:
    s_cmp_eq_u32 s60, 0
    s_cbranch_scc1 k2_pr0_77
    s_setprio 1
    s_branch k2_prd_77
k2_pr0_77:
    s_setprio 0
k2_prd_77:
    s_cmp_le_u32 s20, 0
    s_cbranch_scc1 k2_skip78
    v_mfma_f32_16x16x32_bf16 v[60:63], v[28:31], v[20:23], 0
    v_mfma_f32_16x16x32_bf16 v[64:67], v[28:31], v[24:27], 0
    ds_read_b128 v[28:31], v2 offset:640
    s_waitcnt lgkmcnt(3)
    v_pk_lshlrev_b16 v48, v0, v48 op_sel_hi:[0,1]
    v_pk_lshlrev_b16 v49, v0, v49 op_sel_hi:[0,1]
    v_pk_lshlrev_b16 v50, v0, v50 op_sel_hi:[0,1]
    v_pk_lshlrev_b16 v51, v0, v51 op_sel_hi:[0,1]
    v_pk_ashrrev_i16 v48, 15, v48 op_sel_hi:[0,1]
    v_pk_ashrrev_i16 v49, 15, v49 op_sel_hi:[0,1]
    v_pk_ashrrev_i16 v50, 15, v50 op_sel_hi:[0,1]
    v_pk_ashrrev_i16 v51, 15, v51 op_sel_hi:[0,1]
    s_nop 1
    v_cvt_pk_bf16_f32 v60, v60, v61
    v_cvt_pk_bf16_f32 v61, v62, v63
    v_cvt_pk_bf16_f32 v62, v64, v65
    v_cvt_pk_bf16_f32 v63, v66, v67
    s_waitcnt lgkmcnt(1)
    v_and_b32 v52, v48, v52
    v_and_b32 v53, v49, v53
    v_and_b32 v54, v50, v54
    v_and_b32 v55, v51, v55
    v_and_b32 v56, v48, v56
    v_and_b32 v57, v49, v57
    v_and_b32 v58, v50, v58
    v_and_b32 v59, v51, v59
    v_mfma_f32_16x16x32_bf16 v[116:119], v[60:63], v[52:55], v[116:119]
    s_waitcnt lgkmcnt(0)
    v_and_b32 v28, v48, v28
    v_mfma_f32_16x16x32_bf16 v[120:123], v[60:63], v[56:59], v[120:123]
    v_and_b32 v29, v49, v29
    v_and_b32 v30, v50, v30
    v_and_b32 v31, v51, v31
    s_nop 1
    v_mfma_f32_16x16x32_bf16 v[124:127], v[60:63], v[28:31], v[124:127]
k2_skip78:
    s_waitcnt lgkmcnt(3)
    ds_read_b128 v[48:51], v2 offset:1024
    ds_read_b128 v[52:55], v2 offset:64
    ds_read_b128 v[56:59], v2 offset:384
    s_waitcnt vmcnt(3)
    s_cmp_le_u32 s20, 32
    s_cbranch_scc1 k2_skip79
    v_mfma_f32_16x16x32_bf16 v[60:63], v[32:35], v[20:23], 0
    v_mfma_f32_16x16x32_bf16 v[64:67], v[32:35], v[24:27], 0
    ds_read_b128 v[32:35], v2 offset:704
    s_waitcnt lgkmcnt(3)
    v_pk_lshlrev_b16 v48, v0, v48 op_sel_hi:[0,1]
    v_pk_lshlrev_b16 v49, v0, v49 op_sel_hi:[0,1]
    v_pk_lshlrev_b16 v50, v0, v50 op_sel_hi:[0,1]
    v_pk_lshlrev_b16 v51, v0, v51 op_sel_hi:[0,1]
    v_pk_ashrrev_i16 v48, 15, v48 op_sel_hi:[0,1]
    v_pk_ashrrev_i16 v49, 15, v49 op_sel_hi:[0,1]
    v_pk_ashrrev_i16 v50, 15, v50 op_sel_hi:[0,1]
    v_pk_ashrrev_i16 v51, 15, v51 op_sel_hi:[0,1]
    s_nop 1
    v_cvt_pk_bf16_f32 v60, v60, v61
    v_cvt_pk_bf16_f32 v61, v62, v63
    v_cvt_pk_bf16_f32 v62, v64, v65
    v_cvt_pk_bf16_f32 v63, v66, v67
    s_waitcnt lgkmcnt(1)
    v_and_b32 v52, v48, v52
    v_and_b32 v53, v49, v53
    v_and_b32 v54, v50, v54
    v_and_b32 v55, v51, v55
    v_and_b32 v56, v48, v56
    v_and_b32 v57, v49, v57
    v_and_b32 v58, v50, v58
    v_and_b32 v59, v51, v59
    v_mfma_f32_16x16x32_bf16 v[116:119], v[60:63], v[52:55], v[116:119]
    s_waitcnt lgkmcnt(0)
    v_and_b32 v32, v48, v32
    v_mfma_f32_16x16x32_bf16 v[120:123], v[60:63], v[56:59], v[120:123]
    v_and_b32 v33, v49, v33
    v_and_b32 v34, v50, v34
    v_and_b32 v35, v51, v35
    s_nop 1
    v_mfma_f32_16x16x32_bf16 v[124:127], v[60:63], v[32:35], v[124:127]
k2_skip79:
    s_waitcnt lgkmcnt(3)
    ds_read_b128 v[48:51], v2 offset:1088
    ds_read_b128 v[52:55], v2 offset:128
    ds_read_b128 v[56:59], v2 offset:448
    s_waitcnt vmcnt(2)
    s_add_u32 s60, s60, 1
    s_and_b32 s60, s60, 3
    s_cmp_lt_u32 s60, 2
    s_cbranch_scc1 k2_pr01_80
    s_cmp_eq_u32 s60, 2
    s_cbranch_scc1 k2_pr2_80
    s_setprio 3
    s_branch k2_prd_80
k2_pr2_80:
    s_setprio 2
    s_branch k2_prd_80
k2_pr01_80:
    s_cmp_eq_u32 s60, 0
    s_cbranch_scc1 k2_pr0_80
    s_setprio 1
    s_branch k2_prd_80
k2_pr0_80:
    s_setprio 0
k2_prd_80:
    s_cmp_le_u32 s20, 64
    s_cbranch_scc1 k2_skip81
    v_mfma_f32_16x16x32_bf16 v[60:63], v[36:39], v[20:23], 0
    v_mfma_f32_16x16x32_bf16 v[64:67], v[36:39], v[24:27], 0
    ds_read_b128 v[36:39], v2 offset:768
    s_waitcnt lgkmcnt(3)
    v_pk_lshlrev_b16 v48, v0, v48 op_sel_hi:[0,1]
    v_pk_lshlrev_b16 v49, v0, v49 op_sel_hi:[0,1]
    v_pk_lshlrev_b16 v50, v0, v50 op_sel_hi:[0,1]
    v_pk_lshlrev_b16 v51, v0, v51 op_sel_hi:[0,1]
    v_pk_ashrrev_i16 v48, 15, v48 op_sel_hi:[0,1]
    v_pk_ashrrev_i16 v49, 15, v49 op_sel_hi:[0,1]
    v_pk_ashrrev_i16 v50, 15, v50 op_sel_hi:[0,1]
    v_pk_ashrrev_i16 v51, 15, v51 op_sel_hi:[0,1]
    s_nop 1
    v_cvt_pk_bf16_f32 v60, v60, v61
    v_cvt_pk_bf16_f32 v61, v62, v63
    v_cvt_pk_bf16_f32 v62, v64, v65
    v_cvt_pk_bf16_f32 v63, v66, v67
    s_waitcnt lgkmcnt(1)
    v_and_b32 v52, v48, v52
    v_and_b32 v53, v49, v53
    v_and_b32 v54, v50, v54
    v_and_b32 v55, v51, v55
    v_and_b32 v56, v48, v56
    v_and_b32 v57, v49, v57
    v_and_b32 v58, v50, v58
    v_and_b32 v59, v51, v59
    v_mfma_f32_16x16x32_bf16 v[116:119], v[60:63], v[52:55], v[116:119]
    s_waitcnt lgkmcnt(0)
    v_and_b32 v36, v48, v36
    v_mfma_f32_16x16x32_bf16 v[120:123], v[60:63], v[56:59], v[120:123]
    v_and_b32 v37, v49, v37
    v_and_b32 v38, v50, v38
    v_and_b32 v39, v51, v39
    s_nop 1
    v_mfma_f32_16x16x32_bf16 v[124:127], v[60:63], v[36:39], v[124:127]
k2_skip81:
    s_waitcnt lgkmcnt(3)
    ds_read_b128 v[48:51], v2 offset:1152
    ds_read_b128 v[52:55], v2 offset:192
    ds_read_b128 v[56:59], v2 offset:512
    s_waitcnt vmcnt(1)
    s_cmp_le_u32 s20, 96
    s_cbranch_scc1 k2_skip82
    v_mfma_f32_16x16x32_bf16 v[60:63], v[40:43], v[20:23], 0
    v_mfma_f32_16x16x32_bf16 v[64:67], v[40:43], v[24:27], 0
    ds_read_b128 v[40:43], v2 offset:832
    s_waitcnt lgkmcnt(3)
    v_pk_lshlrev_b16 v48, v0, v48 op_sel_hi:[0,1]
    v_pk_lshlrev_b16 v49, v0, v49 op_sel_hi:[0,1]
    v_pk_lshlrev_b16 v50, v0, v50 op_sel_hi:[0,1]
    v_pk_lshlrev_b16 v51, v0, v51 op_sel_hi:[0,1]
    v_pk_ashrrev_i16 v48, 15, v48 op_sel_hi:[0,1]
    v_pk_ashrrev_i16 v49, 15, v49 op_sel_hi:[0,1]
    v_pk_ashrrev_i16 v50, 15, v50 op_sel_hi:[0,1]
    v_pk_ashrrev_i16 v51, 15, v51 op_sel_hi:[0,1]
    s_nop 1
    v_cvt_pk_bf16_f32 v60, v60, v61
    v_cvt_pk_bf16_f32 v61, v62, v63
    v_cvt_pk_bf16_f32 v62, v64, v65
    v_cvt_pk_bf16_f32 v63, v66, v67
    s_waitcnt lgkmcnt(1)
    v_and_b32 v52, v48, v52
    v_and_b32 v53, v49, v53
    v_and_b32 v54, v50, v54
    v_and_b32 v55, v51, v55
    v_and_b32 v56, v48, v56
    v_and_b32 v57, v49, v57
    v_and_b32 v58, v50, v58
    v_and_b32 v59, v51, v59
    v_mfma_f32_16x16x32_bf16 v[116:119], v[60:63], v[52:55], v[116:119]
    s_waitcnt lgkmcnt(0)
    v_and_b32 v40, v48, v40
    v_mfma_f32_16x16x32_bf16 v[120:123], v[60:63], v[56:59], v[120:123]
    v_and_b32 v41, v49, v41
    v_and_b32 v42, v50, v42
    v_and_b32 v43, v51, v43
    s_nop 1
    v_mfma_f32_16x16x32_bf16 v[124:127], v[60:63], v[40:43], v[124:127]
k2_skip82:
    s_waitcnt lgkmcnt(3)
    s_waitcnt vmcnt(0)
    s_cmp_gt_u32 s20, 128
    s_cbranch_scc1 k2_rare83
k2_rareb83:
    s_waitcnt lgkmcnt(0)
    v_mov_b32 v48, 640
    ds_read_b32 v49, v48
    s_waitcnt lgkmcnt(0)
    v_readfirstlane_b32 s39, v49
    s_cmp_lg_u32 s39, 0
    s_cbranch_scc1 k2_slow
    s_branch k2_epi
k2_epis:
    s_waitcnt vmcnt(0) lgkmcnt(0)
    s_load_dwordx2 s[52:53], s[0:1], 0
    s_load_dwordx2 s[64:65], s[0:1], 88
    s_waitcnt lgkmcnt(0)
    v_and_b32 v6, 15, v0
    v_lshrrev_b32 v7, 4, v0
    s_mul_i32 s39, s35, 80
    s_mul_i32 s40, s36, 1280
    s_add_u32 s39, s39, s40
    v_add_u32 v6, s39, v6
    v_lshlrev_b32 v6, 5, v6
    v_lshl_add_u32 v7, v7, 3, v6
    s_mov_b32 s80, s52
    s_mov_b32 s81, s53
    s_mov_b32 s82, 10240000
    s_mov_b32 s83, 0x00020000
    buffer_load_dwordx2 v[8:9], v7, s[80:83], 0 offen offset:0
    buffer_load_dwordx2 v[10:11], v7, s[80:83], 0 offen offset:512
    buffer_load_dwordx2 v[12:13], v7, s[80:83], 0 offen offset:1024
    buffer_load_dwordx2 v[14:15], v7, s[80:83], 0 offen offset:1536
    buffer_load_dwordx2 v[16:17], v7, s[80:83], 0 offen offset:2048
k2_epi:
    v_and_b32 v2, 15, v0
    v_lshlrev_b32 v4, 3, v0
    v_add_u32 v4, 149504, v4
    v_lshlrev_b32 v5, 4, v0
    v_add_u32 v5, 152064, v5
    s_mul_i32 s39, s35, 80
    v_add_u32 v6, s39, v2
    v_lshlrev_b32 v29, 1, v6
    v_add_u32 v29, 153088, v29
    ds_read_b64 v[30:31], v4 offset:0
    ds_read_b64 v[32:33], v4 offset:512
    ds_read_b64 v[34:35], v4 offset:1024
    ds_read_b64 v[36:37], v4 offset:1536
    ds_read_b64 v[38:39], v4 offset:2048
    s_mul_i32 s39, s35, 2560
    s_add_u32 s39, s39, 77824
    v_lshl_add_u32 v3, v0, 3, s39
    ds_read_b64 v[20:21], v3 offset:0
    ds_read_b64 v[22:23], v3 offset:512
    ds_read_b64 v[24:25], v3 offset:1024
    ds_read_b64 v[26:27], v3 offset:1536
    ds_read_b64 v[28:29], v3 offset:2048
    s_mov_b32 s68, s64
    s_mov_b32 s69, s65
    s_mov_b32 s70, 10240000
    s_mov_b32 s71, 0x00020000
    s_waitcnt lgkmcnt(0)
    s_mov_b32 s40, 0xc1200000
    s_mov_b32 s41, 0x3fb8aa3b
    v_mfma_f32_16x16x16_bf16 v[48:51], v[30:31], v[20:21], 0
    v_mfma_f32_16x16x16_bf16 v[52:55], v[32:33], v[20:21], 0
    v_mfma_f32_16x16x16_bf16 v[56:59], v[34:35], v[20:21], 0
    v_mfma_f32_16x16x16_bf16 v[60:63], v[36:37], v[20:21], 0
    s_nop 4
    v_mul_f32 v48, v48, v68
    v_mul_f32 v49, v49, v69
    v_mul_f32 v50, v50, v70
    v_mul_f32 v51, v51, v71
    v_fma_f32 v48, v52, v72, v48
    v_fma_f32 v49, v53, v73, v49
    v_fma_f32 v50, v54, v74, v50
    v_fma_f32 v51, v55, v75, v51
    v_fma_f32 v48, v56, v76, v48
    v_fma_f32 v49, v57, v77, v49
    v_fma_f32 v50, v58, v78, v50
    v_fma_f32 v51, v59, v79, v51
    v_cvt_pk_bf16_f32 v46, v48, v49
    v_cvt_pk_bf16_f32 v47, v50, v51
    s_nop 1
    v_mfma_f32_16x16x16_bf16 v[52:55], v[38:39], v[46:47], 0
    v_cvt_pk_bf16_f32 v60, 0, v60
    v_cvt_pk_bf16_f32 v61, 0, v61
    v_cvt_pk_bf16_f32 v62, 0, v62
    v_cvt_pk_bf16_f32 v63, 0, v63
    s_nop 3
    v_cvt_pk_bf16_f32 v52, 0, v52
    v_cvt_pk_bf16_f32 v53, 0, v53
    v_cvt_pk_bf16_f32 v54, 0, v54
    v_cvt_pk_bf16_f32 v55, 0, v55
    v_mul_f32 v52, v52, v60
    v_mul_f32 v53, v53, v61
    v_mul_f32 v54, v54, v62
    v_mul_f32 v55, v55, v63
    v_cvt_pk_bf16_f32 v52, 0, v52
    v_cvt_pk_bf16_f32 v53, 0, v53
    v_cvt_pk_bf16_f32 v54, 0, v54
    v_cvt_pk_bf16_f32 v55, 0, v55
    s_waitcnt vmcnt(0)
    v_lshlrev_b32 v56, 16, v8
    v_and_b32 v57, 0xffff0000, v8
    v_lshlrev_b32 v58, 16, v9
    v_and_b32 v59, 0xffff0000, v9
    v_add_f32 v52, v52, v56
    v_add_f32 v53, v53, v57
    v_add_f32 v54, v54, v58
    v_add_f32 v55, v55, v59
    v_cvt_pk_bf16_f32 v64, v52, v53
    v_cvt_pk_bf16_f32 v65, v54, v55
    buffer_store_dwordx2 v[64:65], v7, s[68:71], 0 offen offset:0 nt
    v_mfma_f32_16x16x16_bf16 v[48:51], v[30:31], v[22:23], 0
    v_mfma_f32_16x16x16_bf16 v[52:55], v[32:33], v[22:23], 0
    v_mfma_f32_16x16x16_bf16 v[56:59], v[34:35], v[22:23], 0
    v_mfma_f32_16x16x16_bf16 v[60:63], v[36:37], v[22:23], 0
    s_nop 4
    v_mul_f32 v48, v48, v80
    v_mul_f32 v49, v49, v81
    v_mul_f32 v50, v50, v82
    v_mul_f32 v51, v51, v83
    v_fma_f32 v48, v52, v84, v48
    v_fma_f32 v49, v53, v85, v49
    v_fma_f32 v50, v54, v86, v50
    v_fma_f32 v51, v55, v87, v51
    v_fma_f32 v48, v56, v88, v48
    v_fma_f32 v49, v57, v89, v49
    v_fma_f32 v50, v58, v90, v50
    v_fma_f32 v51, v59, v91, v51
    v_cvt_pk_bf16_f32 v46, v48, v49
    v_cvt_pk_bf16_f32 v47, v50, v51
    s_nop 1
    v_mfma_f32_16x16x16_bf16 v[52:55], v[38:39], v[46:47], 0
    v_cvt_pk_bf16_f32 v60, 0, v60
    v_cvt_pk_bf16_f32 v61, 0, v61
    v_cvt_pk_bf16_f32 v62, 0, v62
    v_cvt_pk_bf16_f32 v63, 0, v63
    s_nop 3
    v_cvt_pk_bf16_f32 v52, 0, v52
    v_cvt_pk_bf16_f32 v53, 0, v53
    v_cvt_pk_bf16_f32 v54, 0, v54
    v_cvt_pk_bf16_f32 v55, 0, v55
    v_mul_f32 v52, v52, v60
    v_mul_f32 v53, v53, v61
    v_mul_f32 v54, v54, v62
    v_mul_f32 v55, v55, v63
    v_cvt_pk_bf16_f32 v52, 0, v52
    v_cvt_pk_bf16_f32 v53, 0, v53
    v_cvt_pk_bf16_f32 v54, 0, v54
    v_cvt_pk_bf16_f32 v55, 0, v55
    v_lshlrev_b32 v56, 16, v10
    v_and_b32 v57, 0xffff0000, v10
    v_lshlrev_b32 v58, 16, v11
    v_and_b32 v59, 0xffff0000, v11
    v_add_f32 v52, v52, v56
    v_add_f32 v53, v53, v57
    v_add_f32 v54, v54, v58
    v_add_f32 v55, v55, v59
    v_cvt_pk_bf16_f32 v66, v52, v53
    v_cvt_pk_bf16_f32 v67, v54, v55
    buffer_store_dwordx2 v[66:67], v7, s[68:71], 0 offen offset:512 nt
    v_mfma_f32_16x16x16_bf16 v[48:51], v[30:31], v[24:25], 0
    v_mfma_f32_16x16x16_bf16 v[52:55], v[32:33], v[24:25], 0
    v_mfma_f32_16x16x16_bf16 v[56:59], v[34:35], v[24:25], 0
    v_mfma_f32_16x16x16_bf16 v[60:63], v[36:37], v[24:25], 0
    s_nop 4
    v_mul_f32 v48, v48, v92
    v_mul_f32 v49, v49, v93
    v_mul_f32 v50, v50, v94
    v_mul_f32 v51, v51, v95
    v_fma_f32 v48, v52, v96, v48
    v_fma_f32 v49, v53, v97, v49
    v_fma_f32 v50, v54, v98, v50
    v_fma_f32 v51, v55, v99, v51
    v_fma_f32 v48, v56, v100, v48
    v_fma_f32 v49, v57, v101, v49
    v_fma_f32 v50, v58, v102, v50
    v_fma_f32 v51, v59, v103, v51
    v_cvt_pk_bf16_f32 v46, v48, v49
    v_cvt_pk_bf16_f32 v47, v50, v51
    s_nop 1
    v_mfma_f32_16x16x16_bf16 v[52:55], v[38:39], v[46:47], 0
    v_cvt_pk_bf16_f32 v60, 0, v60
    v_cvt_pk_bf16_f32 v61, 0, v61
    v_cvt_pk_bf16_f32 v62, 0, v62
    v_cvt_pk_bf16_f32 v63, 0, v63
    s_nop 3
    v_cvt_pk_bf16_f32 v52, 0, v52
    v_cvt_pk_bf16_f32 v53, 0, v53
    v_cvt_pk_bf16_f32 v54, 0, v54
    v_cvt_pk_bf16_f32 v55, 0, v55
    v_mul_f32 v52, v52, v60
    v_mul_f32 v53, v53, v61
    v_mul_f32 v54, v54, v62
    v_mul_f32 v55, v55, v63
    v_cvt_pk_bf16_f32 v52, 0, v52
    v_cvt_pk_bf16_f32 v53, 0, v53
    v_cvt_pk_bf16_f32 v54, 0, v54
    v_cvt_pk_bf16_f32 v55, 0, v55
    v_lshlrev_b32 v56, 16, v12
    v_and_b32 v57, 0xffff0000, v12
    v_lshlrev_b32 v58, 16, v13
    v_and_b32 v59, 0xffff0000, v13
    v_add_f32 v52, v52, v56
    v_add_f32 v53, v53, v57
    v_add_f32 v54, v54, v58
    v_add_f32 v55, v55, v59
    v_cvt_pk_bf16_f32 v64, v52, v53
    v_cvt_pk_bf16_f32 v65, v54, v55
    buffer_store_dwordx2 v[64:65], v7, s[68:71], 0 offen offset:1024 nt
    v_mfma_f32_16x16x16_bf16 v[48:51], v[30:31], v[26:27], 0
    v_mfma_f32_16x16x16_bf16 v[52:55], v[32:33], v[26:27], 0
    v_mfma_f32_16x16x16_bf16 v[56:59], v[34:35], v[26:27], 0
    v_mfma_f32_16x16x16_bf16 v[60:63], v[36:37], v[26:27], 0
    s_nop 4
    v_mul_f32 v48, v48, v104
    v_mul_f32 v49, v49, v105
    v_mul_f32 v50, v50, v106
    v_mul_f32 v51, v51, v107
    v_fma_f32 v48, v52, v108, v48
    v_fma_f32 v49, v53, v109, v49
    v_fma_f32 v50, v54, v110, v50
    v_fma_f32 v51, v55, v111, v51
    v_fma_f32 v48, v56, v112, v48
    v_fma_f32 v49, v57, v113, v49
    v_fma_f32 v50, v58, v114, v50
    v_fma_f32 v51, v59, v115, v51
    v_cvt_pk_bf16_f32 v46, v48, v49
    v_cvt_pk_bf16_f32 v47, v50, v51
    s_nop 1
    v_mfma_f32_16x16x16_bf16 v[52:55], v[38:39], v[46:47], 0
    v_cvt_pk_bf16_f32 v60, 0, v60
    v_cvt_pk_bf16_f32 v61, 0, v61
    v_cvt_pk_bf16_f32 v62, 0, v62
    v_cvt_pk_bf16_f32 v63, 0, v63
    s_nop 3
    v_cvt_pk_bf16_f32 v52, 0, v52
    v_cvt_pk_bf16_f32 v53, 0, v53
    v_cvt_pk_bf16_f32 v54, 0, v54
    v_cvt_pk_bf16_f32 v55, 0, v55
    v_mul_f32 v52, v52, v60
    v_mul_f32 v53, v53, v61
    v_mul_f32 v54, v54, v62
    v_mul_f32 v55, v55, v63
    v_cvt_pk_bf16_f32 v52, 0, v52
    v_cvt_pk_bf16_f32 v53, 0, v53
    v_cvt_pk_bf16_f32 v54, 0, v54
    v_cvt_pk_bf16_f32 v55, 0, v55
    v_lshlrev_b32 v56, 16, v14
    v_and_b32 v57, 0xffff0000, v14
    v_lshlrev_b32 v58, 16, v15
    v_and_b32 v59, 0xffff0000, v15
    v_add_f32 v52, v52, v56
    v_add_f32 v53, v53, v57
    v_add_f32 v54, v54, v58
    v_add_f32 v55, v55, v59
    v_cvt_pk_bf16_f32 v66, v52, v53
    v_cvt_pk_bf16_f32 v67, v54, v55
    buffer_store_dwordx2 v[66:67], v7, s[68:71], 0 offen offset:1536 nt
    v_mfma_f32_16x16x16_bf16 v[48:51], v[30:31], v[28:29], 0
    v_mfma_f32_16x16x16_bf16 v[52:55], v[32:33], v[28:29], 0
    v_mfma_f32_16x16x16_bf16 v[56:59], v[34:35], v[28:29], 0
    v_mfma_f32_16x16x16_bf16 v[60:63], v[36:37], v[28:29], 0
    s_nop 4
    v_mul_f32 v48, v48, v116
    v_mul_f32 v49, v49, v117
    v_mul_f32 v50, v50, v118
    v_mul_f32 v51, v51, v119
    v_fma_f32 v48, v52, v120, v48
    v_fma_f32 v49, v53, v121, v49
    v_fma_f32 v50, v54, v122, v50
    v_fma_f32 v51, v55, v123, v51
    v_fma_f32 v48, v56, v124, v48
    v_fma_f32 v49, v57, v125, v49
    v_fma_f32 v50, v58, v126, v50
    v_fma_f32 v51, v59, v127, v51
    v_cvt_pk_bf16_f32 v46, v48, v49
    v_cvt_pk_bf16_f32 v47, v50, v51
    s_nop 1
    v_mfma_f32_16x16x16_bf16 v[52:55], v[38:39], v[46:47], 0
    v_cvt_pk_bf16_f32 v60, 0, v60
    v_cvt_pk_bf16_f32 v61, 0, v61
    v_cvt_pk_bf16_f32 v62, 0, v62
    v_cvt_pk_bf16_f32 v63, 0, v63
    s_nop 3
    v_cvt_pk_bf16_f32 v52, 0, v52
    v_cvt_pk_bf16_f32 v53, 0, v53
    v_cvt_pk_bf16_f32 v54, 0, v54
    v_cvt_pk_bf16_f32 v55, 0, v55
    v_mul_f32 v52, v52, v60
    v_mul_f32 v53, v53, v61
    v_mul_f32 v54, v54, v62
    v_mul_f32 v55, v55, v63
    v_cvt_pk_bf16_f32 v52, 0, v52
    v_cvt_pk_bf16_f32 v53, 0, v53
    v_cvt_pk_bf16_f32 v54, 0, v54
    v_cvt_pk_bf16_f32 v55, 0, v55
    v_lshlrev_b32 v56, 16, v16
    v_and_b32 v57, 0xffff0000, v16
    v_lshlrev_b32 v58, 16, v17
    v_and_b32 v59, 0xffff0000, v17
    v_add_f32 v52, v52, v56
    v_add_f32 v53, v53, v57
    v_add_f32 v54, v54, v58
    v_add_f32 v55, v55, v59
    v_cvt_pk_bf16_f32 v64, v52, v53
    v_cvt_pk_bf16_f32 v65, v54, v55
    buffer_store_dwordx2 v[64:65], v7, s[68:71], 0 offen offset:2048 nt
    s_endpgm
k2_slow:
    s_waitcnt vmcnt(0) lgkmcnt(0)
    s_load_dwordx2 s[52:53], s[0:1], 0
    s_mov_b32 s34, 0
    s_mul_i32 s39, s35, 3200
    v_and_b32 v18, 15, v0
    v_lshrrev_b32 v10, 5, v0
    v_lshrrev_b32 v19, 2, v18
    v_lshlrev_b32 v19, 3, v19
    v_and_b32 v18, 3, v18
    v_add_u32 v19, v19, v18
    v_lshl_add_u32 v19, v10, 2, v19
    v_lshl_add_u32 v4, v19, 2, s39
    v_lshl_add_u32 v6, v0, 2, s39
    v_lshlrev_b32 v9, 1, v0
    v_sub_u32 v9, v1, v9
    s_mov_b32 s81, s39
    s_waitcnt lgkmcnt(0)
    v_mov_b32 v68, 0
    v_mov_b32 v69, 0
    v_mov_b32 v70, 0
    v_mov_b32 v71, 0
    v_mov_b32 v72, 0
    v_mov_b32 v73, 0
    v_mov_b32 v74, 0
    v_mov_b32 v75, 0
    v_mov_b32 v76, 0
    v_mov_b32 v77, 0
    v_mov_b32 v78, 0
    v_mov_b32 v79, 0
    v_mov_b32 v80, 0
    v_mov_b32 v81, 0
    v_mov_b32 v82, 0
    v_mov_b32 v83, 0
    v_mov_b32 v84, 0
    v_mov_b32 v85, 0
    v_mov_b32 v86, 0
    v_mov_b32 v87, 0
    v_mov_b32 v88, 0
    v_mov_b32 v89, 0
    v_mov_b32 v90, 0
    v_mov_b32 v91, 0
    v_mov_b32 v92, 0
    v_mov_b32 v93, 0
    v_mov_b32 v94, 0
    v_mov_b32 v95, 0
    v_mov_b32 v96, 0
    v_mov_b32 v97, 0
    v_mov_b32 v98, 0
    v_mov_b32 v99, 0
    v_mov_b32 v100, 0
    v_mov_b32 v101, 0
    v_mov_b32 v102, 0
    v_mov_b32 v103, 0
    v_mov_b32 v104, 0
    v_mov_b32 v105, 0
    v_mov_b32 v106, 0
    v_mov_b32 v107, 0
    v_mov_b32 v108, 0
    v_mov_b32 v109, 0
    v_mov_b32 v110, 0
    v_mov_b32 v111, 0
    v_mov_b32 v112, 0
    v_mov_b32 v113, 0
    v_mov_b32 v114, 0
    v_mov_b32 v115, 0
    v_mov_b32 v116, 0
    v_mov_b32 v117, 0
    v_mov_b32 v118, 0
    v_mov_b32 v119, 0
    v_mov_b32 v120, 0
    v_mov_b32 v121, 0
    v_mov_b32 v122, 0
    v_mov_b32 v123, 0
    v_mov_b32 v124, 0
    v_mov_b32 v125, 0
    v_mov_b32 v126, 0
    v_mov_b32 v127, 0
k2_sl_r:
    s_and_b32 s80, s34, 1
    s_mul_i32 s80, s80, 320
    s_add_u32 s80, s80, s44
    s_lshl_b32 s39, s34, 21
    s_add_u32 s4, s52, s39
    s_addc_u32 s5, s53, 0
    s_sub_u32 s39, 10240000, s39
    s_min_u32 s6, s39, 2097152
    s_mov_b32 s61, 0
k2_sl_c:
    s_mul_i32 s40, s61, 5000
    s_mul_i32 s41, s34, 1000
    s_add_u32 s40, s40, s41
    s_lshl_b32 s41, s36, 2
    s_add_u32 s40, s40, s41
    s_load_dword s63, s[54:55], s40
    s_mul_i32 s62, s61, 40960
    s_waitcnt lgkmcnt(0)
    s_and_b32 s39, s63, 0xffff
    s_lshr_b32 s63, s63, 16
    s_add_u32 s62, s62, s39
k2_sl_p:
    s_cmp_eq_u32 s63, 0
    s_cbranch_scc1 k2_sl_n
    s_min_u32 s39, s63, 32
    s_sub_u32 s63, s63, s39
    s_lshl_b32 s26, s39, 2
    s_lshl_b32 s41, s62, 2
    s_lshl_b32 s40, s62, 1
    s_add_u32 s62, s62, s39
    v_mov_b32 v12, 0xffff
    s_bfm_b64 exec, s39, 0
    buffer_load_ushort v12, v3, s[12:15], s40 offen
    buffer_load_dword v7, v1, s[8:11], s41 offen
    s_mov_b64 exec, -1
    s_waitcnt vmcnt(0)
    v_bfe_u32 v10, v12, 4, 12
    v_subrev_u32 v10, s80, v10
    v_cmp_gt_u32 vcc, 20, v10
    s_cbranch_vccz k2_sl_p
    ds_write_b32 v6, v7 offset:26624
    ds_read_u16 v19, v4 offset:26624
    v_and_b32 v49, 0xffff0000, v7
    v_mul_f32 v53, 0.15915494, v49
    v_mul_f32 v55, 0x40400000, v49
    v_fract_f32 v53, v53
    v_cvt_pk_bf16_f32 v55, 0, v55
    v_cos_f32 v53, v53
    v_mul_f32 v55, 0.15915494, v55
    v_fract_f32 v55, v55
    v_mul_f32 v54, v53, v53
    v_cos_f32 v55, v55
    v_fma_f32 v54, 2.0, v54, -1.0
    s_nop 0
    v_cvt_pk_bf16_f32 v53, v53, v54
    v_cvt_pk_bf16_f32 v55, v55, v55
    s_mov_b32 exec_hi, 0
    ds_write_b16 v9, v53 offset:0
    ds_write_b16_d16_hi v9, v53 offset:320
    ds_write_b16 v9, v55 offset:640
    s_mov_b64 exec, -1
    s_waitcnt lgkmcnt(0)
    v_lshlrev_b32 v19, 5, v19
    v_and_or_b32 v19, v0, 16, v19
    s_add_u32 s42, s81, s26
    v_cmp_gt_i32 vcc, s42, v4
    s_mov_b64 exec, vcc
    buffer_load_dwordx4 v[28:31], v19, s[4:7], 0 offen
    s_mov_b64 exec, -1
    s_waitcnt vmcnt(0)
    v_mfma_f32_16x16x32_bf16 v[60:63], v[28:31], v[20:23], 0
    v_mfma_f32_16x16x32_bf16 v[64:67], v[28:31], v[24:27], 0
    s_nop 7
    s_nop 3
    v_cvt_pk_bf16_f32 v60, v60, v61
    v_cvt_pk_bf16_f32 v61, v62, v63
    v_cvt_pk_bf16_f32 v62, v64, v65
    v_cvt_pk_bf16_f32 v63, v66, v67
    v_cmp_eq_u32 vcc, 0, v10
    s_nop 1
    v_cndmask_b32 v18, 16, v12, vcc
    v_lshrrev_b32 v18, v18, s43
    s_mov_b32 exec_hi, 0
    ds_write_b16 v9, v18 offset:960
    s_mov_b64 exec, -1
    ds_read_b128 v[48:51], v2 offset:960
    ds_read_b128 v[52:55], v2 offset:0
    ds_read_b128 v[56:59], v2 offset:320
    ds_read_b128 v[64:67], v2 offset:640
    s_waitcnt lgkmcnt(0)
    v_pk_lshlrev_b16 v48, v0, v48 op_sel_hi:[0,1]
    v_pk_lshlrev_b16 v49, v0, v49 op_sel_hi:[0,1]
    v_pk_lshlrev_b16 v50, v0, v50 op_sel_hi:[0,1]
    v_pk_lshlrev_b16 v51, v0, v51 op_sel_hi:[0,1]
    v_pk_ashrrev_i16 v48, 15, v48 op_sel_hi:[0,1]
    v_pk_ashrrev_i16 v49, 15, v49 op_sel_hi:[0,1]
    v_pk_ashrrev_i16 v50, 15, v50 op_sel_hi:[0,1]
    v_pk_ashrrev_i16 v51, 15, v51 op_sel_hi:[0,1]
    v_and_b32 v52, v48, v52
    v_and_b32 v56, v48, v56
    v_and_b32 v64, v48, v64
    v_and_b32 v53, v49, v53
    v_and_b32 v57, v49, v57
    v_and_b32 v65, v49, v65
    v_and_b32 v54, v50, v54
    v_and_b32 v58, v50, v58
    v_and_b32 v66, v50, v66
    v_and_b32 v55, v51, v55
    v_and_b32 v59, v51, v59
    v_and_b32 v67, v51, v67
    s_nop 1
    v_mfma_f32_16x16x32_bf16 v[68:71], v[60:63], v[52:55], v[68:71]
    v_mfma_f32_16x16x32_bf16 v[72:75], v[60:63], v[56:59], v[72:75]
    v_mfma_f32_16x16x32_bf16 v[76:79], v[60:63], v[64:67], v[76:79]
    s_nop 7
    v_cmp_eq_u32 vcc, 4, v10
    s_nop 1
    v_cndmask_b32 v18, 16, v12, vcc
    v_lshrrev_b32 v18, v18, s43
    s_mov_b32 exec_hi, 0
    ds_write_b16 v9, v18 offset:960
    s_mov_b64 exec, -1
    ds_read_b128 v[48:51], v2 offset:960
    ds_read_b128 v[52:55], v2 offset:0
    ds_read_b128 v[56:59], v2 offset:320
    ds_read_b128 v[64:67], v2 offset:640
    s_waitcnt lgkmcnt(0)
    v_pk_lshlrev_b16 v48, v0, v48 op_sel_hi:[0,1]
    v_pk_lshlrev_b16 v49, v0, v49 op_sel_hi:[0,1]
    v_pk_lshlrev_b16 v50, v0, v50 op_sel_hi:[0,1]
    v_pk_lshlrev_b16 v51, v0, v51 op_sel_hi:[0,1]
    v_pk_ashrrev_i16 v48, 15, v48 op_sel_hi:[0,1]
    v_pk_ashrrev_i16 v49, 15, v49 op_sel_hi:[0,1]
    v_pk_ashrrev_i16 v50, 15, v50 op_sel_hi:[0,1]
    v_pk_ashrrev_i16 v51, 15, v51 op_sel_hi:[0,1]
    v_and_b32 v52, v48, v52
    v_and_b32 v56, v48, v56
    v_and_b32 v64, v48, v64
    v_and_b32 v53, v49, v53
    v_and_b32 v57, v49, v57
    v_and_b32 v65, v49, v65
    v_and_b32 v54, v50, v54
    v_and_b32 v58, v50, v58
    v_and_b32 v66, v50, v66
    v_and_b32 v55, v51, v55
    v_and_b32 v59, v51, v59
    v_and_b32 v67, v51, v67
    s_nop 1
    v_mfma_f32_16x16x32_bf16 v[80:83], v[60:63], v[52:55], v[80:83]
    v_mfma_f32_16x16x32_bf16 v[84:87], v[60:63], v[56:59], v[84:87]
    v_mfma_f32_16x16x32_bf16 v[88:91], v[60:63], v[64:67], v[88:91]
    s_nop 7
    v_cmp_eq_u32 vcc, 8, v10
    s_nop 1
    v_cndmask_b32 v18, 16, v12, vcc
    v_lshrrev_b32 v18, v18, s43
    s_mov_b32 exec_hi, 0
    ds_write_b16 v9, v18 offset:960
    s_mov_b64 exec, -1
    ds_read_b128 v[48:51], v2 offset:960
    ds_read_b128 v[52:55], v2 offset:0
    ds_read_b128 v[56:59], v2 offset:320
    ds_read_b128 v[64:67], v2 offset:640
    s_waitcnt lgkmcnt(0)
    v_pk_lshlrev_b16 v48, v0, v48 op_sel_hi:[0,1]
    v_pk_lshlrev_b16 v49, v0, v49 op_sel_hi:[0,1]
    v_pk_lshlrev_b16 v50, v0, v50 op_sel_hi:[0,1]
    v_pk_lshlrev_b16 v51, v0, v51 op_sel_hi:[0,1]
    v_pk_ashrrev_i16 v48, 15, v48 op_sel_hi:[0,1]
    v_pk_ashrrev_i16 v49, 15, v49 op_sel_hi:[0,1]
    v_pk_ashrrev_i16 v50, 15, v50 op_sel_hi:[0,1]
    v_pk_ashrrev_i16 v51, 15, v51 op_sel_hi:[0,1]
    v_and_b32 v52, v48, v52
    v_and_b32 v56, v48, v56
    v_and_b32 v64, v48, v64
    v_and_b32 v53, v49, v53
    v_and_b32 v57, v49, v57
    v_and_b32 v65, v49, v65
    v_and_b32 v54, v50, v54
    v_and_b32 v58, v50, v58
    v_and_b32 v66, v50, v66
    v_and_b32 v55, v51, v55
    v_and_b32 v59, v51, v59
    v_and_b32 v67, v51, v67
    s_nop 1
    v_mfma_f32_16x16x32_bf16 v[92:95], v[60:63], v[52:55], v[92:95]
    v_mfma_f32_16x16x32_bf16 v[96:99], v[60:63], v[56:59], v[96:99]
    v_mfma_f32_16x16x32_bf16 v[100:103], v[60:63], v[64:67], v[100:103]
    s_nop 7
    v_cmp_eq_u32 vcc, 12, v10
    s_nop 1
    v_cndmask_b32 v18, 16, v12, vcc
    v_lshrrev_b32 v18, v18, s43
    s_mov_b32 exec_hi, 0
    ds_write_b16 v9, v18 offset:960
    s_mov_b64 exec, -1
    ds_read_b128 v[48:51], v2 offset:960
    ds_read_b128 v[52:55], v2 offset:0
    ds_read_b128 v[56:59], v2 offset:320
    ds_read_b128 v[64:67], v2 offset:640
    s_waitcnt lgkmcnt(0)
    v_pk_lshlrev_b16 v48, v0, v48 op_sel_hi:[0,1]
    v_pk_lshlrev_b16 v49, v0, v49 op_sel_hi:[0,1]
    v_pk_lshlrev_b16 v50, v0, v50 op_sel_hi:[0,1]
    v_pk_lshlrev_b16 v51, v0, v51 op_sel_hi:[0,1]
    v_pk_ashrrev_i16 v48, 15, v48 op_sel_hi:[0,1]
    v_pk_ashrrev_i16 v49, 15, v49 op_sel_hi:[0,1]
    v_pk_ashrrev_i16 v50, 15, v50 op_sel_hi:[0,1]
    v_pk_ashrrev_i16 v51, 15, v51 op_sel_hi:[0,1]
    v_and_b32 v52, v48, v52
    v_and_b32 v56, v48, v56
    v_and_b32 v64, v48, v64
    v_and_b32 v53, v49, v53
    v_and_b32 v57, v49, v57
    v_and_b32 v65, v49, v65
    v_and_b32 v54, v50, v54
    v_and_b32 v58, v50, v58
    v_and_b32 v66, v50, v66
    v_and_b32 v55, v51, v55
    v_and_b32 v59, v51, v59
    v_and_b32 v67, v51, v67
    s_nop 1
    v_mfma_f32_16x16x32_bf16 v[104:107], v[60:63], v[52:55], v[104:107]
    v_mfma_f32_16x16x32_bf16 v[108:111], v[60:63], v[56:59], v[108:111]
    v_mfma_f32_16x16x32_bf16 v[112:115], v[60:63], v[64:67], v[112:115]
    s_nop 7
    v_cmp_eq_u32 vcc, 16, v10
    s_nop 1
    v_cndmask_b32 v18, 16, v12, vcc
    v_lshrrev_b32 v18, v18, s43
    s_mov_b32 exec_hi, 0
    ds_write_b16 v9, v18 offset:960
    s_mov_b64 exec, -1
    ds_read_b128 v[48:51], v2 offset:960
    ds_read_b128 v[52:55], v2 offset:0
    ds_read_b128 v[56:59], v2 offset:320
    ds_read_b128 v[64:67], v2 offset:640
    s_waitcnt lgkmcnt(0)
    v_pk_lshlrev_b16 v48, v0, v48 op_sel_hi:[0,1]
    v_pk_lshlrev_b16 v49, v0, v49 op_sel_hi:[0,1]
    v_pk_lshlrev_b16 v50, v0, v50 op_sel_hi:[0,1]
    v_pk_lshlrev_b16 v51, v0, v51 op_sel_hi:[0,1]
    v_pk_ashrrev_i16 v48, 15, v48 op_sel_hi:[0,1]
    v_pk_ashrrev_i16 v49, 15, v49 op_sel_hi:[0,1]
    v_pk_ashrrev_i16 v50, 15, v50 op_sel_hi:[0,1]
    v_pk_ashrrev_i16 v51, 15, v51 op_sel_hi:[0,1]
    v_and_b32 v52, v48, v52
    v_and_b32 v56, v48, v56
    v_and_b32 v64, v48, v64
    v_and_b32 v53, v49, v53
    v_and_b32 v57, v49, v57
    v_and_b32 v65, v49, v65
    v_and_b32 v54, v50, v54
    v_and_b32 v58, v50, v58
    v_and_b32 v66, v50, v66
    v_and_b32 v55, v51, v55
    v_and_b32 v59, v51, v59
    v_and_b32 v67, v51, v67
    s_nop 1
    v_mfma_f32_16x16x32_bf16 v[116:119], v[60:63], v[52:55], v[116:119]
    v_mfma_f32_16x16x32_bf16 v[120:123], v[60:63], v[56:59], v[120:123]
    v_mfma_f32_16x16x32_bf16 v[124:127], v[60:63], v[64:67], v[124:127]
    s_nop 7
    s_branch k2_sl_p
k2_sl_n:
    s_add_u32 s61, s61, 1
    s_cmp_lt_u32 s61, 250
    s_cbranch_scc1 k2_sl_c
    s_add_u32 s34, s34, 1
    s_cmp_lt_u32 s34, 5
    s_cbranch_scc1 k2_sl_r
    s_branch k2_epis
k2_lc1:
    s_mov_b32 s61, 0
k2_lcj1:
    s_lshl_b32 s39, s61, 4
    s_add_u32 s39, s39, s35
    s_cmp_ge_u32 s39, 250
    s_cbranch_scc1 k2_lc_end1
    s_mul_i32 s40, s39, 5000
    s_add_u32 s41, s34, 1
    s_mul_i32 s41, s41, 1000
    s_add_u32 s40, s40, s41
    s_lshl_b32 s41, s36, 2
    s_add_u32 s40, s40, s41
    s_load_dword s63, s[54:55], s40
    s_mul_i32 s62, s39, 40960
    s_waitcnt lgkmcnt(0)
    s_and_b32 s39, s63, 0xffff
    s_lshr_b32 s63, s63, 16
    s_add_u32 s62, s62, s39
k2_lcp1:
    s_cmp_le_u32 s63, 63
    s_cbranch_scc1 k2_lcn1
    s_sub_u32 s63, s63, 63
    s_add_u32 s62, s62, 63
    s_min_u32 s39, s63, 63
    s_bfm_b64 s[70:71], s39, 0
    s_lshl_b32 s41, s62, 2
    s_lshl_b32 s40, s62, 1
    s_mov_b64 exec, s[70:71]
    buffer_load_ushort v14, v3, s[12:15], s40 offen
    buffer_load_dword v9, v1, s[8:11], s41 offen
    s_mov_b64 exec, -1
    s_waitcnt vmcnt(0)
    s_mov_b64 exec, s[70:71]
    v_bfe_u32 v17, v14, 4, 12
    ds_inc_rtn_u32 v18, v17, v1 offset:0
    s_waitcnt lgkmcnt(0)
    s_mov_b64 exec, s[70:71]
    v_min_u32 v18, 159, v18
    v_mad_u32_u24 v18, v17, 40, v18
    ds_write_b8 v18, v14 offset:1024
    v_lshlrev_b32 v18, 2, v18
    ds_write_b32 v18, v9 offset:26624
    s_mov_b64 exec, -1
    s_branch k2_lcp1
k2_lcn1:
    s_add_u32 s61, s61, 1
    s_cmp_lt_u32 s61, 16
    s_cbranch_scc1 k2_lcj1
    s_branch k2_lc_end1
k2_pre_skip9:
    s_waitcnt lgkmcnt(0)
    s_branch k2_pre_end9
k2_pre2_9:
    s_mov_b64 exec, 0xffff
    v_lshlrev_b32 v51, 2, v3
    ds_read_b64 v[48:49], v51 offset:27776
    ds_read_u16 v50, v3 offset:1312
    s_waitcnt lgkmcnt(0)
    v_mov_b32 v51, 0x1010
    v_lshrrev_b32 v52, 8, v50
    v_and_b32 v48, 0xffff0000, v48
    v_and_b32 v49, 0xffff0000, v49
    ds_write_b16 v3, v51 offset:1312
    v_lshrrev_b32 v50, v50, s43
    v_lshrrev_b32 v52, v52, s43
    v_mul_f32 v53, 0.15915494, v48
    v_mul_f32 v55, 0x40400000, v48
    v_mul_f32 v56, 0.15915494, v49
    v_mul_f32 v58, 0x40400000, v49
    v_fract_f32 v53, v53
    v_cvt_pk_bf16_f32 v55, 0, v55
    v_fract_f32 v56, v56
    v_cvt_pk_bf16_f32 v58, 0, v58
    v_cos_f32 v53, v53
    v_mul_f32 v55, 0.15915494, v55
    v_cos_f32 v56, v56
    v_mul_f32 v58, 0.15915494, v58
    v_fract_f32 v55, v55
    v_fract_f32 v58, v58
    v_mul_f32 v54, v53, v53
    v_mul_f32 v57, v56, v56
    v_cos_f32 v55, v55
    v_cos_f32 v58, v58
    v_fma_f32 v54, 2.0, v54, -1.0
    v_fma_f32 v57, 2.0, v57, -1.0
    v_lshl_or_b32 v50, v52, 16, v50
    v_cvt_pk_bf16_f32 v53, v53, v56
    v_cvt_pk_bf16_f32 v55, v55, v58
    ds_write_b32 v1, v50 offset:1216
    v_cvt_pk_bf16_f32 v54, v54, v57
    ds_write_b32 v1, v53 offset:256
    ds_write_b32 v1, v55 offset:896
    ds_write_b32 v1, v54 offset:576
    s_mov_b64 exec, -1
    s_branch k2_pre_end9
k2_rare8:
    v_mfma_f32_16x16x32_bf16 v[60:63], v[44:47], v[20:23], 0
    v_mfma_f32_16x16x32_bf16 v[64:67], v[44:47], v[24:27], 0
    ds_read_b128 v[48:51], v2 offset:1216
    ds_read_b128 v[52:55], v2 offset:256
    ds_read_b128 v[56:59], v2 offset:576
    ds_read_b128 v[44:47], v2 offset:896
    s_waitcnt lgkmcnt(0)
    v_pk_lshlrev_b16 v48, v0, v48 op_sel_hi:[0,1]
    v_pk_lshlrev_b16 v49, v0, v49 op_sel_hi:[0,1]
    v_pk_lshlrev_b16 v50, v0, v50 op_sel_hi:[0,1]
    v_pk_lshlrev_b16 v51, v0, v51 op_sel_hi:[0,1]
    v_pk_ashrrev_i16 v48, 15, v48 op_sel_hi:[0,1]
    v_pk_ashrrev_i16 v49, 15, v49 op_sel_hi:[0,1]
    v_pk_ashrrev_i16 v50, 15, v50 op_sel_hi:[0,1]
    v_pk_ashrrev_i16 v51, 15, v51 op_sel_hi:[0,1]
    s_nop 1
    v_cvt_pk_bf16_f32 v60, v60, v61
    v_cvt_pk_bf16_f32 v61, v62, v63
    v_cvt_pk_bf16_f32 v62, v64, v65
    v_cvt_pk_bf16_f32 v63, v66, v67
    v_and_b32 v52, v48, v52
    v_and_b32 v53, v49, v53
    v_and_b32 v54, v50, v54
    v_and_b32 v55, v51, v55
    v_and_b32 v56, v48, v56
    v_and_b32 v57, v49, v57
    v_and_b32 v58, v50, v58
    v_and_b32 v59, v51, v59
    v_mfma_f32_16x16x32_bf16 v[68:71], v[60:63], v[52:55], v[68:71]
    v_and_b32 v44, v48, v44
    v_mfma_f32_16x16x32_bf16 v[72:75], v[60:63], v[56:59], v[72:75]
    v_and_b32 v45, v49, v45
    v_and_b32 v46, v50, v46
    v_and_b32 v47, v51, v47
    s_nop 1
    v_mfma_f32_16x16x32_bf16 v[76:79], v[60:63], v[44:47], v[76:79]
    v_lshlrev_b32 v51, 2, v3
    ds_read_b64 v[48:49], v51 offset:27264
    ds_read_u16 v50, v3 offset:1184
    s_waitcnt lgkmcnt(0)
    s_branch k2_rareb8
k2_pre_skip17:
    s_waitcnt lgkmcnt(0)
    s_branch k2_pre_end17
k2_pre2_17:
    s_mov_b64 exec, 0xffff
    v_lshlrev_b32 v51, 2, v3
    ds_read_b64 v[48:49], v51 offset:28416
    ds_read_u16 v50, v3 offset:1472
    s_waitcnt lgkmcnt(0)
    v_mov_b32 v51, 0x1010
    v_lshrrev_b32 v52, 8, v50
    v_and_b32 v48, 0xffff0000, v48
    v_and_b32 v49, 0xffff0000, v49
    ds_write_b16 v3, v51 offset:1472
    v_lshrrev_b32 v50, v50, s43
    v_lshrrev_b32 v52, v52, s43
    v_mul_f32 v53, 0.15915494, v48
    v_mul_f32 v55, 0x40400000, v48
    v_mul_f32 v56, 0.15915494, v49
    v_mul_f32 v58, 0x40400000, v49
    v_fract_f32 v53, v53
    v_cvt_pk_bf16_f32 v55, 0, v55
    v_fract_f32 v56, v56
    v_cvt_pk_bf16_f32 v58, 0, v58
    v_cos_f32 v53, v53
    v_mul_f32 v55, 0.15915494, v55
    v_cos_f32 v56, v56
    v_mul_f32 v58, 0.15915494, v58
    v_fract_f32 v55, v55
    v_fract_f32 v58, v58
    v_mul_f32 v54, v53, v53
    v_mul_f32 v57, v56, v56
    v_cos_f32 v55, v55
    v_cos_f32 v58, v58
    v_fma_f32 v54, 2.0, v54, -1.0
    v_fma_f32 v57, 2.0, v57, -1.0
    v_lshl_or_b32 v50, v52, 16, v50
    v_cvt_pk_bf16_f32 v53, v53, v56
    v_cvt_pk_bf16_f32 v55, v55, v58
    ds_write_b32 v1, v50 offset:1216
    v_cvt_pk_bf16_f32 v54, v54, v57
    ds_write_b32 v1, v53 offset:256
    ds_write_b32 v1, v55 offset:896
    ds_write_b32 v1, v54 offset:576
    s_mov_b64 exec, -1
    s_branch k2_pre_end17
k2_rare16:
    v_mfma_f32_16x16x32_bf16 v[60:63], v[44:47], v[20:23], 0
    v_mfma_f32_16x16x32_bf16 v[64:67], v[44:47], v[24:27], 0
    ds_read_b128 v[48:51], v2 offset:1216
    ds_read_b128 v[52:55], v2 offset:256
    ds_read_b128 v[56:59], v2 offset:576
    ds_read_b128 v[44:47], v2 offset:896
    s_waitcnt lgkmcnt(0)
    v_pk_lshlrev_b16 v48, v0, v48 op_sel_hi:[0,1]
    v_pk_lshlrev_b16 v49, v0, v49 op_sel_hi:[0,1]
    v_pk_lshlrev_b16 v50, v0, v50 op_sel_hi:[0,1]
    v_pk_lshlrev_b16 v51, v0, v51 op_sel_hi:[0,1]
    v_pk_ashrrev_i16 v48, 15, v48 op_sel_hi:[0,1]
    v_pk_ashrrev_i16 v49, 15, v49 op_sel_hi:[0,1]
    v_pk_ashrrev_i16 v50, 15, v50 op_sel_hi:[0,1]
    v_pk_ashrrev_i16 v51, 15, v51 op_sel_hi:[0,1]
    s_nop 1
    v_cvt_pk_bf16_f32 v60, v60, v61
    v_cvt_pk_bf16_f32 v61, v62, v63
    v_cvt_pk_bf16_f32 v62, v64, v65
    v_cvt_pk_bf16_f32 v63, v66, v67
    v_and_b32 v52, v48, v52
    v_and_b32 v53, v49, v53
    v_and_b32 v54, v50, v54
    v_and_b32 v55, v51, v55
    v_and_b32 v56, v48, v56
    v_and_b32 v57, v49, v57
    v_and_b32 v58, v50, v58
    v_and_b32 v59, v51, v59
    v_mfma_f32_16x16x32_bf16 v[80:83], v[60:63], v[52:55], v[80:83]
    v_and_b32 v44, v48, v44
    v_mfma_f32_16x16x32_bf16 v[84:87], v[60:63], v[56:59], v[84:87]
    v_and_b32 v45, v49, v45
    v_and_b32 v46, v50, v46
    v_and_b32 v47, v51, v47
    s_nop 1
    v_mfma_f32_16x16x32_bf16 v[88:91], v[60:63], v[44:47], v[88:91]
    v_lshlrev_b32 v51, 2, v3
    ds_read_b64 v[48:49], v51 offset:27904
    ds_read_u16 v50, v3 offset:1344
    s_waitcnt lgkmcnt(0)
    s_branch k2_rareb16
k2_pre_skip25:
    s_waitcnt lgkmcnt(0)
    s_branch k2_pre_end25
k2_pre2_25:
    s_mov_b64 exec, 0xffff
    v_lshlrev_b32 v51, 2, v3
    ds_read_b64 v[48:49], v51 offset:29056
    ds_read_u16 v50, v3 offset:1632
    s_waitcnt lgkmcnt(0)
    v_mov_b32 v51, 0x1010
    v_lshrrev_b32 v52, 8, v50
    v_and_b32 v48, 0xffff0000, v48
    v_and_b32 v49, 0xffff0000, v49
    ds_write_b16 v3, v51 offset:1632
    v_lshrrev_b32 v50, v50, s43
    v_lshrrev_b32 v52, v52, s43
    v_mul_f32 v53, 0.15915494, v48
    v_mul_f32 v55, 0x40400000, v48
    v_mul_f32 v56, 0.15915494, v49
    v_mul_f32 v58, 0x40400000, v49
    v_fract_f32 v53, v53
    v_cvt_pk_bf16_f32 v55, 0, v55
    v_fract_f32 v56, v56
    v_cvt_pk_bf16_f32 v58, 0, v58
    v_cos_f32 v53, v53
    v_mul_f32 v55, 0.15915494, v55
    v_cos_f32 v56, v56
    v_mul_f32 v58, 0.15915494, v58
    v_fract_f32 v55, v55
    v_fract_f32 v58, v58
    v_mul_f32 v54, v53, v53
    v_mul_f32 v57, v56, v56
    v_cos_f32 v55, v55
    v_cos_f32 v58, v58
    v_fma_f32 v54, 2.0, v54, -1.0
    v_fma_f32 v57, 2.0, v57, -1.0
    v_lshl_or_b32 v50, v52, 16, v50
    v_cvt_pk_bf16_f32 v53, v53, v56
    v_cvt_pk_bf16_f32 v55, v55, v58
    ds_write_b32 v1, v50 offset:1216
    v_cvt_pk_bf16_f32 v54, v54, v57
    ds_write_b32 v1, v53 offset:256
    ds_write_b32 v1, v55 offset:896
    ds_write_b32 v1, v54 offset:576
    s_mov_b64 exec, -1
    s_branch k2_pre_end25
k2_rare24:
    v_mfma_f32_16x16x32_bf16 v[60:63], v[44:47], v[20:23], 0
    v_mfma_f32_16x16x32_bf16 v[64:67], v[44:47], v[24:27], 0
    ds_read_b128 v[48:51], v2 offset:1216
    ds_read_b128 v[52:55], v2 offset:256
    ds_read_b128 v[56:59], v2 offset:576
    ds_read_b128 v[44:47], v2 offset:896
    s_waitcnt lgkmcnt(0)
    v_pk_lshlrev_b16 v48, v0, v48 op_sel_hi:[0,1]
    v_pk_lshlrev_b16 v49, v0, v49 op_sel_hi:[0,1]
    v_pk_lshlrev_b16 v50, v0, v50 op_sel_hi:[0,1]
    v_pk_lshlrev_b16 v51, v0, v51 op_sel_hi:[0,1]
    v_pk_ashrrev_i16 v48, 15, v48 op_sel_hi:[0,1]
    v_pk_ashrrev_i16 v49, 15, v49 op_sel_hi:[0,1]
    v_pk_ashrrev_i16 v50, 15, v50 op_sel_hi:[0,1]
    v_pk_ashrrev_i16 v51, 15, v51 op_sel_hi:[0,1]
    s_nop 1
    v_cvt_pk_bf16_f32 v60, v60, v61
    v_cvt_pk_bf16_f32 v61, v62, v63
    v_cvt_pk_bf16_f32 v62, v64, v65
    v_cvt_pk_bf16_f32 v63, v66, v67
    v_and_b32 v52, v48, v52
    v_and_b32 v53, v49, v53
    v_and_b32 v54, v50, v54
    v_and_b32 v55, v51, v55
    v_and_b32 v56, v48, v56
    v_and_b32 v57, v49, v57
    v_and_b32 v58, v50, v58
    v_and_b32 v59, v51, v59
    v_mfma_f32_16x16x32_bf16 v[92:95], v[60:63], v[52:55], v[92:95]
    v_and_b32 v44, v48, v44
    v_mfma_f32_16x16x32_bf16 v[96:99], v[60:63], v[56:59], v[96:99]
    v_and_b32 v45, v49, v45
    v_and_b32 v46, v50, v46
    v_and_b32 v47, v51, v47
    s_nop 1
    v_mfma_f32_16x16x32_bf16 v[100:103], v[60:63], v[44:47], v[100:103]
    v_lshlrev_b32 v51, 2, v3
    ds_read_b64 v[48:49], v51 offset:28544
    ds_read_u16 v50, v3 offset:1504
    s_waitcnt lgkmcnt(0)
    s_branch k2_rareb24
k2_pre2_33:
    s_mov_b64 exec, 0xffff
    v_lshlrev_b32 v51, 2, v3
    ds_read_b64 v[48:49], v51 offset:29696
    ds_read_u16 v50, v3 offset:1792
    s_waitcnt lgkmcnt(0)
    v_mov_b32 v51, 0x1010
    v_lshrrev_b32 v52, 8, v50
    v_and_b32 v48, 0xffff0000, v48
    v_and_b32 v49, 0xffff0000, v49
    ds_write_b16 v3, v51 offset:1792
    v_lshrrev_b32 v50, v50, s43
    v_lshrrev_b32 v52, v52, s43
    v_mul_f32 v53, 0.15915494, v48
    v_mul_f32 v55, 0x40400000, v48
    v_mul_f32 v56, 0.15915494, v49
    v_mul_f32 v58, 0x40400000, v49
    v_fract_f32 v53, v53
    v_cvt_pk_bf16_f32 v55, 0, v55
    v_fract_f32 v56, v56
    v_cvt_pk_bf16_f32 v58, 0, v58
    v_cos_f32 v53, v53
    v_mul_f32 v55, 0.15915494, v55
    v_cos_f32 v56, v56
    v_mul_f32 v58, 0.15915494, v58
    v_fract_f32 v55, v55
    v_fract_f32 v58, v58
    v_mul_f32 v54, v53, v53
    v_mul_f32 v57, v56, v56
    v_cos_f32 v55, v55
    v_cos_f32 v58, v58
    v_fma_f32 v54, 2.0, v54, -1.0
    v_fma_f32 v57, 2.0, v57, -1.0
    v_lshl_or_b32 v50, v52, 16, v50
    v_cvt_pk_bf16_f32 v53, v53, v56
    v_cvt_pk_bf16_f32 v55, v55, v58
    ds_write_b32 v1, v50 offset:1216
    v_cvt_pk_bf16_f32 v54, v54, v57
    ds_write_b32 v1, v53 offset:256
    ds_write_b32 v1, v55 offset:896
    ds_write_b32 v1, v54 offset:576
    s_mov_b64 exec, -1
    s_branch k2_pre_end33
k2_rare32:
    v_mfma_f32_16x16x32_bf16 v[60:63], v[44:47], v[20:23], 0
    v_mfma_f32_16x16x32_bf16 v[64:67], v[44:47], v[24:27], 0
    ds_read_b128 v[48:51], v2 offset:1216
    ds_read_b128 v[52:55], v2 offset:256
    ds_read_b128 v[56:59], v2 offset:576
    ds_read_b128 v[44:47], v2 offset:896
    s_waitcnt lgkmcnt(0)
    v_pk_lshlrev_b16 v48, v0, v48 op_sel_hi:[0,1]
    v_pk_lshlrev_b16 v49, v0, v49 op_sel_hi:[0,1]
    v_pk_lshlrev_b16 v50, v0, v50 op_sel_hi:[0,1]
    v_pk_lshlrev_b16 v51, v0, v51 op_sel_hi:[0,1]
    v_pk_ashrrev_i16 v48, 15, v48 op_sel_hi:[0,1]
    v_pk_ashrrev_i16 v49, 15, v49 op_sel_hi:[0,1]
    v_pk_ashrrev_i16 v50, 15, v50 op_sel_hi:[0,1]
    v_pk_ashrrev_i16 v51, 15, v51 op_sel_hi:[0,1]
    s_nop 1
    v_cvt_pk_bf16_f32 v60, v60, v61
    v_cvt_pk_bf16_f32 v61, v62, v63
    v_cvt_pk_bf16_f32 v62, v64, v65
    v_cvt_pk_bf16_f32 v63, v66, v67
    v_and_b32 v52, v48, v52
    v_and_b32 v53, v49, v53
    v_and_b32 v54, v50, v54
    v_and_b32 v55, v51, v55
    v_and_b32 v56, v48, v56
    v_and_b32 v57, v49, v57
    v_and_b32 v58, v50, v58
    v_and_b32 v59, v51, v59
    v_mfma_f32_16x16x32_bf16 v[104:107], v[60:63], v[52:55], v[104:107]
    v_and_b32 v44, v48, v44
    v_mfma_f32_16x16x32_bf16 v[108:111], v[60:63], v[56:59], v[108:111]
    v_and_b32 v45, v49, v45
    v_and_b32 v46, v50, v46
    v_and_b32 v47, v51, v47
    s_nop 1
    v_mfma_f32_16x16x32_bf16 v[112:115], v[60:63], v[44:47], v[112:115]
    v_lshlrev_b32 v51, 2, v3
    ds_read_b64 v[48:49], v51 offset:29184
    ds_read_u16 v50, v3 offset:1664
    s_waitcnt lgkmcnt(0)
    s_branch k2_rareb32
k2_lc34:
    s_mov_b32 s61, 0
k2_lcj34:
    s_lshl_b32 s39, s61, 4
    s_add_u32 s39, s39, s35
    s_cmp_ge_u32 s39, 250
    s_cbranch_scc1 k2_lc_end34
    s_mul_i32 s40, s39, 5000
    s_add_u32 s41, s34, 1
    s_mul_i32 s41, s41, 1000
    s_add_u32 s40, s40, s41
    s_lshl_b32 s41, s36, 2
    s_add_u32 s40, s40, s41
    s_load_dword s63, s[54:55], s40
    s_mul_i32 s62, s39, 40960
    s_waitcnt lgkmcnt(0)
    s_and_b32 s39, s63, 0xffff
    s_lshr_b32 s63, s63, 16
    s_add_u32 s62, s62, s39
k2_lcp34:
    s_cmp_le_u32 s63, 63
    s_cbranch_scc1 k2_lcn34
    s_sub_u32 s63, s63, 63
    s_add_u32 s62, s62, 63
    s_min_u32 s39, s63, 63
    s_bfm_b64 s[70:71], s39, 0
    s_lshl_b32 s41, s62, 2
    s_lshl_b32 s40, s62, 1
    s_mov_b64 exec, s[70:71]
    buffer_load_ushort v14, v3, s[12:15], s40 offen
    buffer_load_dword v9, v1, s[8:11], s41 offen
    s_mov_b64 exec, -1
    s_waitcnt vmcnt(0)
    s_mov_b64 exec, s[70:71]
    v_bfe_u32 v17, v14, 4, 12
    ds_inc_rtn_u32 v18, v17, v1 offset:0
    s_waitcnt lgkmcnt(0)
    s_mov_b64 exec, s[70:71]
    v_min_u32 v18, 159, v18
    v_mad_u32_u24 v18, v17, 40, v18
    ds_write_b8 v18, v14 offset:1024
    v_lshlrev_b32 v18, 2, v18
    ds_write_b32 v18, v9 offset:26624
    s_mov_b64 exec, -1
    s_branch k2_lcp34
k2_lcn34:
    s_add_u32 s61, s61, 1
    s_cmp_lt_u32 s61, 16
    s_cbranch_scc1 k2_lcj34
    s_branch k2_lc_end34
k2_pre2_43:
    s_mov_b64 exec, 0xffff
    v_lshlrev_b32 v51, 2, v3
    ds_read_b64 v[48:49], v51 offset:27136
    ds_read_u16 v50, v3 offset:1152
    s_waitcnt lgkmcnt(0)
    v_mov_b32 v51, 0x1010
    v_lshrrev_b32 v52, 8, v50
    v_and_b32 v48, 0xffff0000, v48
    v_and_b32 v49, 0xffff0000, v49
    ds_write_b16 v3, v51 offset:1152
    v_lshrrev_b32 v50, v50, s43
    v_lshrrev_b32 v52, v52, s43
    v_mul_f32 v53, 0.15915494, v48
    v_mul_f32 v55, 0x40400000, v48
    v_mul_f32 v56, 0.15915494, v49
    v_mul_f32 v58, 0x40400000, v49
    v_fract_f32 v53, v53
    v_cvt_pk_bf16_f32 v55, 0, v55
    v_fract_f32 v56, v56
    v_cvt_pk_bf16_f32 v58, 0, v58
    v_cos_f32 v53, v53
    v_mul_f32 v55, 0.15915494, v55
    v_cos_f32 v56, v56
    v_mul_f32 v58, 0.15915494, v58
    v_fract_f32 v55, v55
    v_fract_f32 v58, v58
    v_mul_f32 v54, v53, v53
    v_mul_f32 v57, v56, v56
    v_cos_f32 v55, v55
    v_cos_f32 v58, v58
    v_fma_f32 v54, 2.0, v54, -1.0
    v_fma_f32 v57, 2.0, v57, -1.0
    v_lshl_or_b32 v50, v52, 16, v50
    v_cvt_pk_bf16_f32 v53, v53, v56
    v_cvt_pk_bf16_f32 v55, v55, v58
    ds_write_b32 v1, v50 offset:1216
    v_cvt_pk_bf16_f32 v54, v54, v57
    ds_write_b32 v1, v53 offset:256
    ds_write_b32 v1, v55 offset:896
    ds_write_b32 v1, v54 offset:576
    s_mov_b64 exec, -1
    s_branch k2_pre_end43
k2_rare42:
    v_mfma_f32_16x16x32_bf16 v[60:63], v[44:47], v[20:23], 0
    v_mfma_f32_16x16x32_bf16 v[64:67], v[44:47], v[24:27], 0
    ds_read_b128 v[48:51], v2 offset:1216
    ds_read_b128 v[52:55], v2 offset:256
    ds_read_b128 v[56:59], v2 offset:576
    ds_read_b128 v[44:47], v2 offset:896
    s_waitcnt lgkmcnt(0)
    v_pk_lshlrev_b16 v48, v0, v48 op_sel_hi:[0,1]
    v_pk_lshlrev_b16 v49, v0, v49 op_sel_hi:[0,1]
    v_pk_lshlrev_b16 v50, v0, v50 op_sel_hi:[0,1]
    v_pk_lshlrev_b16 v51, v0, v51 op_sel_hi:[0,1]
    v_pk_ashrrev_i16 v48, 15, v48 op_sel_hi:[0,1]
    v_pk_ashrrev_i16 v49, 15, v49 op_sel_hi:[0,1]
    v_pk_ashrrev_i16 v50, 15, v50 op_sel_hi:[0,1]
    v_pk_ashrrev_i16 v51, 15, v51 op_sel_hi:[0,1]
    s_nop 1
    v_cvt_pk_bf16_f32 v60, v60, v61
    v_cvt_pk_bf16_f32 v61, v62, v63
    v_cvt_pk_bf16_f32 v62, v64, v65
    v_cvt_pk_bf16_f32 v63, v66, v67
    v_and_b32 v52, v48, v52
    v_and_b32 v53, v49, v53
    v_and_b32 v54, v50, v54
    v_and_b32 v55, v51, v55
    v_and_b32 v56, v48, v56
    v_and_b32 v57, v49, v57
    v_and_b32 v58, v50, v58
    v_and_b32 v59, v51, v59
    v_mfma_f32_16x16x32_bf16 v[116:119], v[60:63], v[52:55], v[116:119]
    v_and_b32 v44, v48, v44
    v_mfma_f32_16x16x32_bf16 v[120:123], v[60:63], v[56:59], v[120:123]
    v_and_b32 v45, v49, v45
    v_and_b32 v46, v50, v46
    v_and_b32 v47, v51, v47
    s_nop 1
    v_mfma_f32_16x16x32_bf16 v[124:127], v[60:63], v[44:47], v[124:127]
    v_lshlrev_b32 v51, 2, v3
    ds_read_b64 v[48:49], v51 offset:26624
    ds_read_u16 v50, v3 offset:1024
    s_waitcnt lgkmcnt(0)
    s_branch k2_rareb42
k2_pre2_51:
    s_mov_b64 exec, 0xffff
    v_lshlrev_b32 v51, 2, v3
    ds_read_b64 v[48:49], v51 offset:27776
    ds_read_u16 v50, v3 offset:1312
    s_waitcnt lgkmcnt(0)
    v_mov_b32 v51, 0x1010
    v_lshrrev_b32 v52, 8, v50
    v_and_b32 v48, 0xffff0000, v48
    v_and_b32 v49, 0xffff0000, v49
    ds_write_b16 v3, v51 offset:1312
    v_lshrrev_b32 v50, v50, s43
    v_lshrrev_b32 v52, v52, s43
    v_mul_f32 v53, 0.15915494, v48
    v_mul_f32 v55, 0x40400000, v48
    v_mul_f32 v56, 0.15915494, v49
    v_mul_f32 v58, 0x40400000, v49
    v_fract_f32 v53, v53
    v_cvt_pk_bf16_f32 v55, 0, v55
    v_fract_f32 v56, v56
    v_cvt_pk_bf16_f32 v58, 0, v58
    v_cos_f32 v53, v53
    v_mul_f32 v55, 0.15915494, v55
    v_cos_f32 v56, v56
    v_mul_f32 v58, 0.15915494, v58
    v_fract_f32 v55, v55
    v_fract_f32 v58, v58
    v_mul_f32 v54, v53, v53
    v_mul_f32 v57, v56, v56
    v_cos_f32 v55, v55
    v_cos_f32 v58, v58
    v_fma_f32 v54, 2.0, v54, -1.0
    v_fma_f32 v57, 2.0, v57, -1.0
    v_lshl_or_b32 v50, v52, 16, v50
    v_cvt_pk_bf16_f32 v53, v53, v56
    v_cvt_pk_bf16_f32 v55, v55, v58
    ds_write_b32 v1, v50 offset:1216
    v_cvt_pk_bf16_f32 v54, v54, v57
    ds_write_b32 v1, v53 offset:256
    ds_write_b32 v1, v55 offset:896
    ds_write_b32 v1, v54 offset:576
    s_mov_b64 exec, -1
    s_branch k2_pre_end51
k2_rare50:
    v_mfma_f32_16x16x32_bf16 v[60:63], v[44:47], v[20:23], 0
    v_mfma_f32_16x16x32_bf16 v[64:67], v[44:47], v[24:27], 0
    ds_read_b128 v[48:51], v2 offset:1216
    ds_read_b128 v[52:55], v2 offset:256
    ds_read_b128 v[56:59], v2 offset:576
    ds_read_b128 v[44:47], v2 offset:896
    s_waitcnt lgkmcnt(0)
    v_pk_lshlrev_b16 v48, v0, v48 op_sel_hi:[0,1]
    v_pk_lshlrev_b16 v49, v0, v49 op_sel_hi:[0,1]
    v_pk_lshlrev_b16 v50, v0, v50 op_sel_hi:[0,1]
    v_pk_lshlrev_b16 v51, v0, v51 op_sel_hi:[0,1]
    v_pk_ashrrev_i16 v48, 15, v48 op_sel_hi:[0,1]
    v_pk_ashrrev_i16 v49, 15, v49 op_sel_hi:[0,1]
    v_pk_ashrrev_i16 v50, 15, v50 op_sel_hi:[0,1]
    v_pk_ashrrev_i16 v51, 15, v51 op_sel_hi:[0,1]
    s_nop 1
    v_cvt_pk_bf16_f32 v60, v60, v61
    v_cvt_pk_bf16_f32 v61, v62, v63
    v_cvt_pk_bf16_f32 v62, v64, v65
    v_cvt_pk_bf16_f32 v63, v66, v67
    v_and_b32 v52, v48, v52
    v_and_b32 v53, v49, v53
    v_and_b32 v54, v50, v54
    v_and_b32 v55, v51, v55
    v_and_b32 v56, v48, v56
    v_and_b32 v57, v49, v57
    v_and_b32 v58, v50, v58
    v_and_b32 v59, v51, v59
    v_mfma_f32_16x16x32_bf16 v[68:71], v[60:63], v[52:55], v[68:71]
    v_and_b32 v44, v48, v44
    v_mfma_f32_16x16x32_bf16 v[72:75], v[60:63], v[56:59], v[72:75]
    v_and_b32 v45, v49, v45
    v_and_b32 v46, v50, v46
    v_and_b32 v47, v51, v47
    s_nop 1
    v_mfma_f32_16x16x32_bf16 v[76:79], v[60:63], v[44:47], v[76:79]
    v_lshlrev_b32 v51, 2, v3
    ds_read_b64 v[48:49], v51 offset:27264
    ds_read_u16 v50, v3 offset:1184
    s_waitcnt lgkmcnt(0)
    s_branch k2_rareb50
k2_pre2_59:
    s_mov_b64 exec, 0xffff
    v_lshlrev_b32 v51, 2, v3
    ds_read_b64 v[48:49], v51 offset:28416
    ds_read_u16 v50, v3 offset:1472
    s_waitcnt lgkmcnt(0)
    v_mov_b32 v51, 0x1010
    v_lshrrev_b32 v52, 8, v50
    v_and_b32 v48, 0xffff0000, v48
    v_and_b32 v49, 0xffff0000, v49
    ds_write_b16 v3, v51 offset:1472
    v_lshrrev_b32 v50, v50, s43
    v_lshrrev_b32 v52, v52, s43
    v_mul_f32 v53, 0.15915494, v48
    v_mul_f32 v55, 0x40400000, v48
    v_mul_f32 v56, 0.15915494, v49
    v_mul_f32 v58, 0x40400000, v49
    v_fract_f32 v53, v53
    v_cvt_pk_bf16_f32 v55, 0, v55
    v_fract_f32 v56, v56
    v_cvt_pk_bf16_f32 v58, 0, v58
    v_cos_f32 v53, v53
    v_mul_f32 v55, 0.15915494, v55
    v_cos_f32 v56, v56
    v_mul_f32 v58, 0.15915494, v58
    v_fract_f32 v55, v55
    v_fract_f32 v58, v58
    v_mul_f32 v54, v53, v53
    v_mul_f32 v57, v56, v56
    v_cos_f32 v55, v55
    v_cos_f32 v58, v58
    v_fma_f32 v54, 2.0, v54, -1.0
    v_fma_f32 v57, 2.0, v57, -1.0
    v_lshl_or_b32 v50, v52, 16, v50
    v_cvt_pk_bf16_f32 v53, v53, v56
    v_cvt_pk_bf16_f32 v55, v55, v58
    ds_write_b32 v1, v50 offset:1216
    v_cvt_pk_bf16_f32 v54, v54, v57
    ds_write_b32 v1, v53 offset:256
    ds_write_b32 v1, v55 offset:896
    ds_write_b32 v1, v54 offset:576
    s_mov_b64 exec, -1
    s_branch k2_pre_end59
k2_rare58:
    v_mfma_f32_16x16x32_bf16 v[60:63], v[44:47], v[20:23], 0
    v_mfma_f32_16x16x32_bf16 v[64:67], v[44:47], v[24:27], 0
    ds_read_b128 v[48:51], v2 offset:1216
    ds_read_b128 v[52:55], v2 offset:256
    ds_read_b128 v[56:59], v2 offset:576
    ds_read_b128 v[44:47], v2 offset:896
    s_waitcnt lgkmcnt(0)
    v_pk_lshlrev_b16 v48, v0, v48 op_sel_hi:[0,1]
    v_pk_lshlrev_b16 v49, v0, v49 op_sel_hi:[0,1]
    v_pk_lshlrev_b16 v50, v0, v50 op_sel_hi:[0,1]
    v_pk_lshlrev_b16 v51, v0, v51 op_sel_hi:[0,1]
    v_pk_ashrrev_i16 v48, 15, v48 op_sel_hi:[0,1]
    v_pk_ashrrev_i16 v49, 15, v49 op_sel_hi:[0,1]
    v_pk_ashrrev_i16 v50, 15, v50 op_sel_hi:[0,1]
    v_pk_ashrrev_i16 v51, 15, v51 op_sel_hi:[0,1]
    s_nop 1
    v_cvt_pk_bf16_f32 v60, v60, v61
    v_cvt_pk_bf16_f32 v61, v62, v63
    v_cvt_pk_bf16_f32 v62, v64, v65
    v_cvt_pk_bf16_f32 v63, v66, v67
    v_and_b32 v52, v48, v52
    v_and_b32 v53, v49, v53
    v_and_b32 v54, v50, v54
    v_and_b32 v55, v51, v55
    v_and_b32 v56, v48, v56
    v_and_b32 v57, v49, v57
    v_and_b32 v58, v50, v58
    v_and_b32 v59, v51, v59
    v_mfma_f32_16x16x32_bf16 v[80:83], v[60:63], v[52:55], v[80:83]
    v_and_b32 v44, v48, v44
    v_mfma_f32_16x16x32_bf16 v[84:87], v[60:63], v[56:59], v[84:87]
    v_and_b32 v45, v49, v45
    v_and_b32 v46, v50, v46
    v_and_b32 v47, v51, v47
    s_nop 1
    v_mfma_f32_16x16x32_bf16 v[88:91], v[60:63], v[44:47], v[88:91]
    v_lshlrev_b32 v51, 2, v3
    ds_read_b64 v[48:49], v51 offset:27904
    ds_read_u16 v50, v3 offset:1344
    s_waitcnt lgkmcnt(0)
    s_branch k2_rareb58
k2_pre2_68:
    s_mov_b64 exec, 0xffff
    v_lshlrev_b32 v51, 2, v3
    ds_read_b64 v[48:49], v51 offset:29056
    ds_read_u16 v50, v3 offset:1632
    s_waitcnt lgkmcnt(0)
    v_mov_b32 v51, 0x1010
    v_lshrrev_b32 v52, 8, v50
    v_and_b32 v48, 0xffff0000, v48
    v_and_b32 v49, 0xffff0000, v49
    ds_write_b16 v3, v51 offset:1632
    v_lshrrev_b32 v50, v50, s43
    v_lshrrev_b32 v52, v52, s43
    v_mul_f32 v53, 0.15915494, v48
    v_mul_f32 v55, 0x40400000, v48
    v_mul_f32 v56, 0.15915494, v49
    v_mul_f32 v58, 0x40400000, v49
    v_fract_f32 v53, v53
    v_cvt_pk_bf16_f32 v55, 0, v55
    v_fract_f32 v56, v56
    v_cvt_pk_bf16_f32 v58, 0, v58
    v_cos_f32 v53, v53
    v_mul_f32 v55, 0.15915494, v55
    v_cos_f32 v56, v56
    v_mul_f32 v58, 0.15915494, v58
    v_fract_f32 v55, v55
    v_fract_f32 v58, v58
    v_mul_f32 v54, v53, v53
    v_mul_f32 v57, v56, v56
    v_cos_f32 v55, v55
    v_cos_f32 v58, v58
    v_fma_f32 v54, 2.0, v54, -1.0
    v_fma_f32 v57, 2.0, v57, -1.0
    v_lshl_or_b32 v50, v52, 16, v50
    v_cvt_pk_bf16_f32 v53, v53, v56
    v_cvt_pk_bf16_f32 v55, v55, v58
    ds_write_b32 v1, v50 offset:1216
    v_cvt_pk_bf16_f32 v54, v54, v57
    ds_write_b32 v1, v53 offset:256
    ds_write_b32 v1, v55 offset:896
    ds_write_b32 v1, v54 offset:576
    s_mov_b64 exec, -1
    s_branch k2_pre_end68
k2_rare67:
    v_mfma_f32_16x16x32_bf16 v[60:63], v[44:47], v[20:23], 0
    v_mfma_f32_16x16x32_bf16 v[64:67], v[44:47], v[24:27], 0
    ds_read_b128 v[48:51], v2 offset:1216
    ds_read_b128 v[52:55], v2 offset:256
    ds_read_b128 v[56:59], v2 offset:576
    ds_read_b128 v[44:47], v2 offset:896
    s_waitcnt lgkmcnt(0)
    v_pk_lshlrev_b16 v48, v0, v48 op_sel_hi:[0,1]
    v_pk_lshlrev_b16 v49, v0, v49 op_sel_hi:[0,1]
    v_pk_lshlrev_b16 v50, v0, v50 op_sel_hi:[0,1]
    v_pk_lshlrev_b16 v51, v0, v51 op_sel_hi:[0,1]
    v_pk_ashrrev_i16 v48, 15, v48 op_sel_hi:[0,1]
    v_pk_ashrrev_i16 v49, 15, v49 op_sel_hi:[0,1]
    v_pk_ashrrev_i16 v50, 15, v50 op_sel_hi:[0,1]
    v_pk_ashrrev_i16 v51, 15, v51 op_sel_hi:[0,1]
    s_nop 1
    v_cvt_pk_bf16_f32 v60, v60, v61
    v_cvt_pk_bf16_f32 v61, v62, v63
    v_cvt_pk_bf16_f32 v62, v64, v65
    v_cvt_pk_bf16_f32 v63, v66, v67
    v_and_b32 v52, v48, v52
    v_and_b32 v53, v49, v53
    v_and_b32 v54, v50, v54
    v_and_b32 v55, v51, v55
    v_and_b32 v56, v48, v56
    v_and_b32 v57, v49, v57
    v_and_b32 v58, v50, v58
    v_and_b32 v59, v51, v59
    v_mfma_f32_16x16x32_bf16 v[92:95], v[60:63], v[52:55], v[92:95]
    v_and_b32 v44, v48, v44
    v_mfma_f32_16x16x32_bf16 v[96:99], v[60:63], v[56:59], v[96:99]
    v_and_b32 v45, v49, v45
    v_and_b32 v46, v50, v46
    v_and_b32 v47, v51, v47
    s_nop 1
    v_mfma_f32_16x16x32_bf16 v[100:103], v[60:63], v[44:47], v[100:103]
    v_lshlrev_b32 v51, 2, v3
    ds_read_b64 v[48:49], v51 offset:28544
    ds_read_u16 v50, v3 offset:1504
    s_waitcnt lgkmcnt(0)
    s_branch k2_rareb67
k2_pre2_76:
    s_mov_b64 exec, 0xffff
    v_lshlrev_b32 v51, 2, v3
    ds_read_b64 v[48:49], v51 offset:29696
    ds_read_u16 v50, v3 offset:1792
    s_waitcnt lgkmcnt(0)
    v_mov_b32 v51, 0x1010
    v_lshrrev_b32 v52, 8, v50
    v_and_b32 v48, 0xffff0000, v48
    v_and_b32 v49, 0xffff0000, v49
    ds_write_b16 v3, v51 offset:1792
    v_lshrrev_b32 v50, v50, s43
    v_lshrrev_b32 v52, v52, s43
    v_mul_f32 v53, 0.15915494, v48
    v_mul_f32 v55, 0x40400000, v48
    v_mul_f32 v56, 0.15915494, v49
    v_mul_f32 v58, 0x40400000, v49
    v_fract_f32 v53, v53
    v_cvt_pk_bf16_f32 v55, 0, v55
    v_fract_f32 v56, v56
    v_cvt_pk_bf16_f32 v58, 0, v58
    v_cos_f32 v53, v53
    v_mul_f32 v55, 0.15915494, v55
    v_cos_f32 v56, v56
    v_mul_f32 v58, 0.15915494, v58
    v_fract_f32 v55, v55
    v_fract_f32 v58, v58
    v_mul_f32 v54, v53, v53
    v_mul_f32 v57, v56, v56
    v_cos_f32 v55, v55
    v_cos_f32 v58, v58
    v_fma_f32 v54, 2.0, v54, -1.0
    v_fma_f32 v57, 2.0, v57, -1.0
    v_lshl_or_b32 v50, v52, 16, v50
    v_cvt_pk_bf16_f32 v53, v53, v56
    v_cvt_pk_bf16_f32 v55, v55, v58
    ds_write_b32 v1, v50 offset:1216
    v_cvt_pk_bf16_f32 v54, v54, v57
    ds_write_b32 v1, v53 offset:256
    ds_write_b32 v1, v55 offset:896
    ds_write_b32 v1, v54 offset:576
    s_mov_b64 exec, -1
    s_branch k2_pre_end76
k2_rare75:
    v_mfma_f32_16x16x32_bf16 v[60:63], v[44:47], v[20:23], 0
    v_mfma_f32_16x16x32_bf16 v[64:67], v[44:47], v[24:27], 0
    ds_read_b128 v[48:51], v2 offset:1216
    ds_read_b128 v[52:55], v2 offset:256
    ds_read_b128 v[56:59], v2 offset:576
    ds_read_b128 v[44:47], v2 offset:896
    s_waitcnt lgkmcnt(0)
    v_pk_lshlrev_b16 v48, v0, v48 op_sel_hi:[0,1]
    v_pk_lshlrev_b16 v49, v0, v49 op_sel_hi:[0,1]
    v_pk_lshlrev_b16 v50, v0, v50 op_sel_hi:[0,1]
    v_pk_lshlrev_b16 v51, v0, v51 op_sel_hi:[0,1]
    v_pk_ashrrev_i16 v48, 15, v48 op_sel_hi:[0,1]
    v_pk_ashrrev_i16 v49, 15, v49 op_sel_hi:[0,1]
    v_pk_ashrrev_i16 v50, 15, v50 op_sel_hi:[0,1]
    v_pk_ashrrev_i16 v51, 15, v51 op_sel_hi:[0,1]
    s_nop 1
    v_cvt_pk_bf16_f32 v60, v60, v61
    v_cvt_pk_bf16_f32 v61, v62, v63
    v_cvt_pk_bf16_f32 v62, v64, v65
    v_cvt_pk_bf16_f32 v63, v66, v67
    v_and_b32 v52, v48, v52
    v_and_b32 v53, v49, v53
    v_and_b32 v54, v50, v54
    v_and_b32 v55, v51, v55
    v_and_b32 v56, v48, v56
    v_and_b32 v57, v49, v57
    v_and_b32 v58, v50, v58
    v_and_b32 v59, v51, v59
    v_mfma_f32_16x16x32_bf16 v[104:107], v[60:63], v[52:55], v[104:107]
    v_and_b32 v44, v48, v44
    v_mfma_f32_16x16x32_bf16 v[108:111], v[60:63], v[56:59], v[108:111]
    v_and_b32 v45, v49, v45
    v_and_b32 v46, v50, v46
    v_and_b32 v47, v51, v47
    s_nop 1
    v_mfma_f32_16x16x32_bf16 v[112:115], v[60:63], v[44:47], v[112:115]
    v_lshlrev_b32 v51, 2, v3
    ds_read_b64 v[48:49], v51 offset:29184
    ds_read_u16 v50, v3 offset:1664
    s_waitcnt lgkmcnt(0)
    s_branch k2_rareb75
k2_rare83:
    v_mfma_f32_16x16x32_bf16 v[60:63], v[44:47], v[20:23], 0
    v_mfma_f32_16x16x32_bf16 v[64:67], v[44:47], v[24:27], 0
    ds_read_b128 v[48:51], v2 offset:1216
    ds_read_b128 v[52:55], v2 offset:256
    ds_read_b128 v[56:59], v2 offset:576
    ds_read_b128 v[44:47], v2 offset:896
    s_waitcnt lgkmcnt(0)
    v_pk_lshlrev_b16 v48, v0, v48 op_sel_hi:[0,1]
    v_pk_lshlrev_b16 v49, v0, v49 op_sel_hi:[0,1]
    v_pk_lshlrev_b16 v50, v0, v50 op_sel_hi:[0,1]
    v_pk_lshlrev_b16 v51, v0, v51 op_sel_hi:[0,1]
    v_pk_ashrrev_i16 v48, 15, v48 op_sel_hi:[0,1]
    v_pk_ashrrev_i16 v49, 15, v49 op_sel_hi:[0,1]
    v_pk_ashrrev_i16 v50, 15, v50 op_sel_hi:[0,1]
    v_pk_ashrrev_i16 v51, 15, v51 op_sel_hi:[0,1]
    s_nop 1
    v_cvt_pk_bf16_f32 v60, v60, v61
    v_cvt_pk_bf16_f32 v61, v62, v63
    v_cvt_pk_bf16_f32 v62, v64, v65
    v_cvt_pk_bf16_f32 v63, v66, v67
    v_and_b32 v52, v48, v52
    v_and_b32 v53, v49, v53
    v_and_b32 v54, v50, v54
    v_and_b32 v55, v51, v55
    v_and_b32 v56, v48, v56
    v_and_b32 v57, v49, v57
    v_and_b32 v58, v50, v58
    v_and_b32 v59, v51, v59
    v_mfma_f32_16x16x32_bf16 v[116:119], v[60:63], v[52:55], v[116:119]
    v_and_b32 v44, v48, v44
    v_mfma_f32_16x16x32_bf16 v[120:123], v[60:63], v[56:59], v[120:123]
    v_and_b32 v45, v49, v45
    v_and_b32 v46, v50, v46
    v_and_b32 v47, v51, v47
    s_nop 1
    v_mfma_f32_16x16x32_bf16 v[124:127], v[60:63], v[44:47], v[124:127]
    s_branch k2_rareb83
k2_end:
    s_endpgm
.section .rodata,"a"
.p2align 6
.amdhsa_kernel k1_kernel
  .amdhsa_next_free_vgpr 124
  .amdhsa_next_free_sgpr 102
  .amdhsa_accum_offset 124
  .amdhsa_group_segment_fixed_size 0
  .amdhsa_kernarg_size 112
  .amdhsa_user_sgpr_count 2
  .amdhsa_user_sgpr_kernarg_segment_ptr 1
  .amdhsa_system_sgpr_workgroup_id_x 1
.end_amdhsa_kernel
.p2align 6
.amdhsa_kernel k2_kernel
  .amdhsa_next_free_vgpr 128
  .amdhsa_next_free_sgpr 102
  .amdhsa_accum_offset 128
  .amdhsa_group_segment_fixed_size 0
  .amdhsa_kernarg_size 112
  .amdhsa_user_sgpr_count 2
  .amdhsa_user_sgpr_kernarg_segment_ptr 1
  .amdhsa_system_sgpr_workgroup_id_x 1
.end_amdhsa_kernel
```
